```python
import torch

def _softmax(x, axis=-1):
    return torch.softmax(x, dim=axis)
def _gelu(x):
    return torch.nn.functional.gelu(x, approximate="tanh")
def _silu(x):
    return torch.nn.functional.silu(x)
def _sigmoid(x):
    return torch.sigmoid(x)
def _layernorm(x, axis=-1, eps=1e-5):
    m = x.mean(dim=axis, keepdim=True)
    v = x.var(dim=axis, keepdim=True, unbiased=False)
    return (x - m) / torch.sqrt(v + eps)
def _scatter_add(tgt, idx, src, axis=0):
    return tgt.clone().index_add_(axis, idx, src)
def _segment_sum(src, seg, n):
    out = torch.zeros((n,) + src.shape[1:], dtype=src.dtype)
    return out.index_add_(0, seg, src)
def _pad(x, pw):
    flat = tuple(v for pair in reversed(pw) for v in pair)
    return torch.nn.functional.pad(x, flat)

kernel_name = 'recurrent_scan__ssm_conv_h3__dense_activation_squared_relu__prompt'

def setup_inputs():

    _w = (lambda a: (lambda t: t.to(torch.bfloat16) if t.is_floating_point() else t)(torch.as_tensor(a)))
    def _A_setup():
        B, S, D = 1, 2048, 512
        ks = 4
        return {
            "q": _w((lambda *s: torch.randn(*s, dtype=torch.bfloat16) * 0.05)(B, S, D)),
            "k": _w((lambda *s: torch.randn(*s, dtype=torch.bfloat16) * 0.2)(B, S, D)),
            "v": _w((lambda *s: torch.randn(*s, dtype=torch.bfloat16) * 0.2)(B, S, D)),
            "shift_k": _w((lambda *s: torch.randn(*s, dtype=torch.bfloat16) * 0.2)(D, ks) * 0.5),
            "ssm_k": _w((lambda *s: torch.randn(*s, dtype=torch.bfloat16) * 0.2)(D, S) * (1.0 / S ** 0.5)),
            "ssm_D": _w((lambda *s: torch.randn(*s, dtype=torch.bfloat16) * 0.2)(D)),
        }
    _A_in = _A_setup()

    def _B_setup():
        B, S, D, F = 1, 2048, 512, 1792
        return {
            "x": _w((lambda *s: torch.randn(*s, dtype=torch.bfloat16) * 0.05)(B, S, D)),
            "w1": _w((lambda *s: torch.randn(*s, dtype=torch.bfloat16) * 0.1)(D, F)),
            "b1": _w((lambda *s: torch.randn(*s, dtype=torch.bfloat16) * 0.8)(F)),
            "w2": _w((lambda *s: torch.randn(*s, dtype=torch.bfloat16) * 0.1)(F, D)),
            "b2": _w((lambda *s: torch.randn(*s, dtype=torch.bfloat16) * 6.4)(D)),
        }
    _B_in = _B_setup()

    return {
        "A_q": _A_in["q"],
        "A_k": _A_in["k"],
        "A_v": _A_in["v"],
        "A_shift_k": _A_in["shift_k"],
        "A_ssm_k": _A_in["ssm_k"],
        "A_ssm_D": _A_in["ssm_D"],
        "B_x": _B_in["x"],
        "B_w1": _B_in["w1"],
        "B_b1": _B_in["b1"],
        "B_w2": _B_in["w2"],
        "B_b2": _B_in["b2"],
    }

def reference(A_q, A_k, A_v, A_shift_k, A_ssm_k, A_ssm_D, B_x, B_w1, B_b1, B_w2, B_b2):
    def _A_ref(q, k, v, shift_k, ssm_k, ssm_D):
        B, S, D = q.shape
        ks = shift_k.shape[-1]
        k_pad = _pad(k, ((0, 0), (ks - 1, 0), (0, 0)))
        k_shift = torch.zeros_like(k)
        for t in range(ks):
            k_shift = k_shift + k_pad[:, t:t + S, :] * shift_k[:, ks - 1 - t][None, None, :]
        kv = k_shift * v
        L = 2 * S
        kv_pad = _pad(kv, ((0, 0), (0, S), (0, 0)))
        kf_pad = _pad(ssm_k, ((0, 0), (0, S)))
        kv_f = (lambda x, axes=(-2,-1): torch.fft.rfft2(x.float(), dim=axes))(kv_pad[:, None, :, :], axes=(1, 2))
        kf_f = (lambda x, axes=(-2,-1): torch.fft.rfft2(x.float(), dim=axes))(kf_pad[:, None, :], axes=(1, 2))
        kf_f = (lambda x, *d: x.permute(*d))(kf_f, 1, 2, 0)
        y_f = kv_f * kf_f[None, :, :, :]
        y = (lambda x, s, axes=(-2,-1): torch.fft.irfft2(x, s=s, dim=axes).to(torch.bfloat16))(y_f, (1, L), axes=(1, 2))[:, 0, :S, :]
        y = y + kv * ssm_D[None, None, :]
        return q * y

    def _B_ref(x, w1, b1, w2, b2):
        h = torch.einsum("bsd,df->bsf", x, w1) + b1
        zero = torch.zeros_like(h)
        r = torch.where(h > zero, h, zero)
        h = r * r
        out = torch.einsum("bsf,fd->bsd", h, w2) + b2
        return out

    x = A_q
    xn = _layernorm(x, axis=-1)
    s = _A_ref(xn, A_k, A_v, A_shift_k, A_ssm_k, A_ssm_D)
    g = _silu(_B_ref(xn, B_w1, B_b1, B_w2, B_b2))
    return x + s * g
```

```asm
; @launch grid=(256,1,1) block=(256,1,1) lds=163840
.amdgcn_target "amdgcn-amd-amdhsa--gfx950"
.text
.globl recurrent_scan__ssm_conv_h3__dense_activation_squared_relu__prompt_kernel
.p2align 8
.type recurrent_scan__ssm_conv_h3__dense_activation_squared_relu__prompt_kernel,@function
recurrent_scan__ssm_conv_h3__dense_activation_squared_relu__prompt_kernel:
    s_cmp_ge_u32 s2, 256
    s_cbranch_scc1 Lend
    s_load_dwordx16 s[4:19], s[0:1], 0
    s_load_dwordx8 s[20:27], s[0:1], 64
    s_load_dwordx4 s[28:31], s[0:1], 96
    v_and_b32 v1, 63, v0
    v_lshrrev_b32 v2, 6, v0
    s_nop 0
    v_readfirstlane_b32 s3, v2
    s_and_b32 s90, s2, 0x38
    s_cmp_lg_u32 s90, 0
    s_cbranch_scc1 Lcpf1
    s_getpc_b64 s[90:91]
Lpcbase:
    v_lshlrev_b32 v63, 7, v0
    v_min_u32 v63, Lend-Lpcbase, v63
    global_load_dword v63, v63, s[90:91]
Lcpf1:
    s_and_b32 s61, s2, 7
    s_lshr_b32 s62, s2, 3
    s_lshr_b32 s63, s61, 1
    s_lshl_b32 s63, s63, 9
    s_and_b32 s64, s62, 3
    s_lshl_b32 s64, s64, 7
    s_add_u32 s63, s63, s64
    s_and_b32 s64, s61, 1
    s_mul_i32 s64, s64, 896
    s_lshr_b32 s65, s62, 2
    s_lshl_b32 s65, s65, 7
    s_add_u32 s64, s64, s65
    s_and_b32 s70, s3, 1
    s_lshr_b32 s71, s3, 1
    s_and_b32 s69, s62, 3
    s_lshl_b32 s69, s69, 1
    s_lshr_b32 s65, s62, 2
    s_add_u32 s65, s65, s69
    s_and_b32 s65, s65, 7
    s_waitcnt lgkmcnt(0)
    s_mov_b32 s32, s30
    s_mov_b32 s33, s31
    s_mov_b32 s34, 0x10000000
    s_mov_b32 s35, 0x20000
    v_mov_b32 v42, 14712832
    buffer_load_dword v62, v42, s[32:35], 0 offen sc1
    s_and_b32 s58, s2, 7
    s_lshr_b32 s59, s58, 1
    s_lshl_b32 s59, s59, 9
    s_and_b32 s58, s58, 1
    s_lshl_b32 s58, s58, 5
    s_lshr_b32 s60, s2, 3
    s_add_u32 s58, s58, s60
    s_lshl_b32 s58, s58, 3
    s_add_u32 s58, s58, s59
    s_lshl_b32 s59, s3, 1
    s_add_u32 s58, s58, s59
    s_lshl_b32 s59, s58, 10
    v_lshl_add_u32 v42, v1, 4, s59
    s_mov_b32 s92, s4
    s_mov_b32 s93, s5
    s_mov_b32 s94, 0x200000
    s_mov_b32 s95, 0x20000
    buffer_load_dwordx4 v[32:35], v42, s[92:95], 0 offen
    buffer_load_dwordx4 v[36:39], v42, s[92:95], 0 offen offset:1024
    s_and_b32 s81, s2, 7
    s_lshl_b32 s81, s81, 8
    s_lshr_b32 s82, s2, 3
    s_and_b32 s83, s82, 3
    s_lshl_b32 s84, s83, 6
    s_add_u32 s81, s81, s84
    s_lshr_b32 s82, s82, 2
    s_lshl_b32 s83, s83, 1
    s_add_u32 s84, s82, s83
    s_cmp_ge_u32 s84, 7
    s_cselect_b32 s83, 7, 0
    s_sub_u32 s84, s84, s83
    s_cmp_ge_u32 s84, 7
    s_cselect_b32 s83, 7, 0
    s_sub_u32 s84, s84, s83
    s_mov_b32 s84, 0
    s_lshl_b32 s84, s84, 12
    s_mov_b32 s86, s84
    s_lshl_b32 s82, s82, 6
    s_lshr_b32 s83, s82, 5
    s_mul_i32 s83, s83, 112
    s_mul_i32 s45, s3, 28
    s_add_u32 s83, s83, s45
    s_lshl_b32 s83, s83, 10
    s_add_u32 s83, s83, 4194304
    s_lshr_b32 s85, s81, 5
    s_mul_i32 s85, s85, 112
    s_add_u32 s85, s85, s45
    s_lshl_b32 s85, s85, 10
    s_add_u32 s85, s85, 6291456
    s_cmp_ge_u32 s62, 28
    s_cbranch_scc1 Lidle
    s_mov_b32 s36, s18
    s_mov_b32 s37, s19
    s_mov_b32 s38, 0x1c0000
    s_mov_b32 s39, 0x20000
    s_mov_b32 s40, s4
    s_mov_b32 s41, s5
    s_mov_b32 s42, 0x200000
    s_mov_b32 s43, 0x20000
    v_lshrrev_b32 v24, 4, v1
    v_mul_u32_u24 v8, 3584, v24
    v_lshlrev_b32 v25, 2, v24
    v_and_b32 v26, 15, v1
    v_xor_b32 v25, v25, v26
    v_lshl_add_u32 v8, v25, 4, v8
    v_lshrrev_b32 v25, 3, v1
    v_lshlrev_b32 v25, 10, v25
    v_and_b32 v26, 7, v1
    v_xor_b32 v27, v26, v24
    v_lshl_add_u32 v9, v27, 4, v25
    v_xor_b32 v27, 4, v27
    v_lshl_add_u32 v10, v27, 4, v25
    s_mul_i32 s66, s3, 57344
    s_lshl_b32 s69, s64, 1
    s_add_u32 s66, s66, s69
    s_lshl_b32 s67, s3, 5
    s_add_u32 s67, s67, s63
    s_lshl_b32 s67, s67, 10
    s_lshl_b32 s68, s3, 12
    s_lshr_b32 s48, s2, 3
    s_lshl_b32 s48, s48, 6
    s_and_b32 s49, s2, 7
    s_lshl_b32 s49, s49, 7
    v_lshrrev_b32 v42, 3, v1
    v_lshlrev_b32 v42, 10, v42
    v_and_b32 v43, 7, v1
    v_lshl_add_u32 v42, v43, 4, v42
    s_lshl_b32 s50, s48, 10
    s_add_u32 s50, s50, s49
    s_sub_u32 s51, s50, 8192
    v_add_u32 v43, s51, v42
    s_lshl_b32 s51, s3, 14
    s_add_u32 s51, s51, s50
    s_lshl_b32 s52, s3, 11
    v_and_b32 v44, 15, v1
    s_lshl_b32 s59, s3, 4
    s_lshr_b32 s60, s49, 1
    s_add_u32 s59, s59, s60
    v_add_u32 v58, s59, v44
    v_lshlrev_b32 v44, 3, v58
    s_mov_b32 s96, s6
    s_mov_b32 s97, s7
    s_mov_b32 s98, 0x200000
    s_mov_b32 s99, 0x20000
    s_cmp_lg_u32 s3, 0
    s_cbranch_scc1 Lpre_hist776_0
    s_mov_b32 m0, 131072
    s_nop 0
    buffer_load_dwordx4 v43, s[96:99], 0 offen lds
Lpre_hist776_0:
    s_add_u32 s53, s51, 0
    s_add_u32 m0, s52, 132096
    s_nop 0
    buffer_load_dwordx4 v42, s[96:99], s53 offen lds
    s_add_u32 s53, s51, 8192
    s_add_u32 m0, s52, 133120
    s_nop 0
    buffer_load_dwordx4 v42, s[96:99], s53 offen lds
    s_mov_b32 s96, s8
    s_mov_b32 s97, s9
    s_mov_b32 s98, 0x200000
    s_mov_b32 s99, 0x20000
    s_add_u32 s53, s51, 0
    s_add_u32 m0, s52, 140288
    s_nop 0
    buffer_load_dwordx4 v42, s[96:99], s53 offen lds
    s_add_u32 s53, s51, 8192
    s_add_u32 m0, s52, 141312
    s_nop 0
    buffer_load_dwordx4 v42, s[96:99], s53 offen lds
    s_mov_b32 s92, s10
    s_mov_b32 s93, s11
    s_mov_b32 s94, 0x1000
    s_mov_b32 s95, 0x20000
    buffer_load_dwordx2 v[40:41], v44, s[92:95], 0 offen
    s_add_u32 s46, s65, 0
    s_and_b32 s46, s46, 7
    s_lshl_b32 s47, s46, 7
    s_add_u32 s47, s47, s67
    s_mul_i32 s46, s46, 229376
    s_add_u32 s46, s46, s66
    s_add_u32 m0, s68, 0
    s_add_u32 s69, s46, 0
    buffer_load_dwordx4 v8, s[36:39], s69 offen lds
    s_add_u32 m0, s68, 16384
    s_add_u32 s69, s47, 0
    buffer_load_dwordx4 v9, s[40:43], s69 offen lds
    s_add_u32 m0, s68, 1024
    s_add_u32 s69, s46, 14336
    buffer_load_dwordx4 v8, s[36:39], s69 offen lds
    s_add_u32 m0, s68, 17408
    s_add_u32 s69, s47, 8192
    buffer_load_dwordx4 v10, s[40:43], s69 offen lds
    s_add_u32 m0, s68, 2048
    s_add_u32 s69, s46, 28672
    buffer_load_dwordx4 v8, s[36:39], s69 offen lds
    s_add_u32 m0, s68, 18432
    s_add_u32 s69, s47, 16384
    buffer_load_dwordx4 v9, s[40:43], s69 offen lds
    s_add_u32 m0, s68, 3072
    s_add_u32 s69, s46, 43008
    buffer_load_dwordx4 v8, s[36:39], s69 offen lds
    s_add_u32 m0, s68, 19456
    s_add_u32 s69, s47, 24576
    buffer_load_dwordx4 v10, s[40:43], s69 offen lds
    s_add_u32 s46, s65, 1
    s_and_b32 s46, s46, 7
    s_lshl_b32 s47, s46, 7
    s_add_u32 s47, s47, s67
    s_mul_i32 s46, s46, 229376
    s_add_u32 s46, s46, s66
    s_add_u32 m0, s68, 32768
    s_add_u32 s69, s46, 0
    buffer_load_dwordx4 v8, s[36:39], s69 offen lds
    s_add_u32 m0, s68, 49152
    s_add_u32 s69, s47, 0
    buffer_load_dwordx4 v9, s[40:43], s69 offen lds
    s_add_u32 m0, s68, 33792
    s_add_u32 s69, s46, 14336
    buffer_load_dwordx4 v8, s[36:39], s69 offen lds
    s_add_u32 m0, s68, 50176
    s_add_u32 s69, s47, 8192
    buffer_load_dwordx4 v10, s[40:43], s69 offen lds
    s_add_u32 m0, s68, 34816
    s_add_u32 s69, s46, 28672
    buffer_load_dwordx4 v8, s[36:39], s69 offen lds
    s_add_u32 m0, s68, 51200
    s_add_u32 s69, s47, 16384
    buffer_load_dwordx4 v9, s[40:43], s69 offen lds
    s_add_u32 m0, s68, 35840
    s_add_u32 s69, s46, 43008
    buffer_load_dwordx4 v8, s[36:39], s69 offen lds
    s_add_u32 m0, s68, 52224
    s_add_u32 s69, s47, 24576
    buffer_load_dwordx4 v10, s[40:43], s69 offen lds
    s_lshl_b32 s73, s2, 13
    v_lshl_add_u32 v244, v0, 4, s73
    v_subrev_u32 v245, 8, v244
    v_max_i32 v245, 0, v245
    v_add_u32 v246, 4096, v244
    v_add_u32 v247, 4096, v245
    s_lshl_b32 s74, s2, 2
    s_load_dword s75, s[14:15], s74
    s_lshl_b32 s69, s64, 1
    v_lshl_add_u32 v252, v1, 4, s69
    v_lshrrev_b32 v24, 5, v1
    v_lshlrev_b32 v24, 3, v24
    v_bfe_u32 v25, v1, 2, 2
    v_add_u32 v24, v24, v25
    v_lshlrev_b32 v24, 8, v24
    v_and_b32 v26, 1, v1
    v_lshl_add_u32 v24, v26, 3, v24
    v_bfe_u32 v26, v1, 4, 1
    v_lshlrev_b32 v26, 1, v26
    v_bfe_u32 v27, v1, 1, 1
    v_add_u32 v26, v26, v27
    s_lshl_b32 s69, s70, 3
    v_add_u32 v26, s69, v26
    v_lshlrev_b32 v25, 2, v25
    s_lshl_b32 s69, s71, 2
    s_xor_b32 s72, s69, 0
    v_add_u32 v27, s72, v26
    v_xor_b32 v27, v27, v25
    v_lshl_add_u32 v12, v27, 4, v24
    v_add_u32 v13, 0x10000, v12
    s_xor_b32 s72, s69, 4
    v_add_u32 v27, s72, v26
    v_xor_b32 v27, v27, v25
    v_lshl_add_u32 v14, v27, 4, v24
    v_add_u32 v15, 0x10000, v14
    v_and_b32 v24, 31, v1
    s_lshl_b32 s69, s71, 6
    v_add_u32 v24, s69, v24
    v_lshlrev_b32 v24, 7, v24
    v_add_u32 v24, 16384, v24
    v_bfe_u32 v25, v1, 1, 3
    v_lshrrev_b32 v26, 5, v1
    v_xor_b32 v25, v25, v26
    v_xor_b32 v26, 0, v25
    v_lshl_add_u32 v16, v26, 4, v24
    v_add_u32 v17, 0x10000, v16
    v_xor_b32 v26, 2, v25
    v_lshl_add_u32 v18, v26, 4, v24
    v_add_u32 v19, 0x10000, v18
    v_xor_b32 v26, 4, v25
    v_lshl_add_u32 v20, v26, 4, v24
    v_add_u32 v21, 0x10000, v20
    v_xor_b32 v26, 6, v25
    v_lshl_add_u32 v22, v26, 4, v24
    v_add_u32 v23, 0x10000, v22
    v_bfe_u32 v24, v1, 4, 1
    v_and_b32 v25, 1, v1
    v_cmp_eq_u32 vcc, v24, v25
    v_mov_b32 v26, 0x3f803f80
    s_nop 0
    v_cndmask_b32 v168, 0, v26, vcc
    v_cndmask_b32 v169, 0, v26, vcc
    v_cndmask_b32 v170, 0, v26, vcc
    v_cndmask_b32 v171, 0, v26, vcc
    v_mov_b64 v[64:65], 0
    v_mov_b64 v[66:67], 0
    v_mov_b64 v[68:69], 0
    v_mov_b64 v[70:71], 0
    v_mov_b64 v[72:73], 0
    v_mov_b64 v[74:75], 0
    v_mov_b64 v[76:77], 0
    v_mov_b64 v[78:79], 0
    v_mov_b64 v[80:81], 0
    v_mov_b64 v[82:83], 0
    v_mov_b64 v[84:85], 0
    v_mov_b64 v[86:87], 0
    v_mov_b64 v[88:89], 0
    v_mov_b64 v[90:91], 0
    v_mov_b64 v[92:93], 0
    v_mov_b64 v[94:95], 0
    v_mov_b64 v[96:97], 0
    v_mov_b64 v[98:99], 0
    v_mov_b64 v[100:101], 0
    v_mov_b64 v[102:103], 0
    v_mov_b64 v[104:105], 0
    v_mov_b64 v[106:107], 0
    v_mov_b64 v[108:109], 0
    v_mov_b64 v[110:111], 0
    v_mov_b64 v[112:113], 0
    v_mov_b64 v[114:115], 0
    v_mov_b64 v[116:117], 0
    v_mov_b64 v[118:119], 0
    v_mov_b64 v[120:121], 0
    v_mov_b64 v[122:123], 0
    v_mov_b64 v[124:125], 0
    v_mov_b64 v[126:127], 0
    v_mov_b64 v[160:161], 0
    v_mov_b64 v[162:163], 0
    s_add_u32 s46, s65, 2
    s_and_b32 s46, s46, 7
    s_lshl_b32 s47, s46, 7
    s_add_u32 s47, s47, s67
    s_mul_i32 s46, s46, 229376
    s_add_u32 s46, s46, s66
    s_add_u32 m0, s68, 65536
    s_add_u32 s69, s46, 0
    buffer_load_dwordx4 v8, s[36:39], s69 offen lds
    s_add_u32 m0, s68, 81920
    s_add_u32 s69, s47, 0
    buffer_load_dwordx4 v9, s[40:43], s69 offen lds
    s_add_u32 m0, s68, 66560
    s_add_u32 s69, s46, 14336
    buffer_load_dwordx4 v8, s[36:39], s69 offen lds
    s_add_u32 m0, s68, 82944
    s_add_u32 s69, s47, 8192
    buffer_load_dwordx4 v10, s[40:43], s69 offen lds
    s_add_u32 m0, s68, 67584
    s_add_u32 s69, s46, 28672
    buffer_load_dwordx4 v8, s[36:39], s69 offen lds
    s_add_u32 m0, s68, 83968
    s_add_u32 s69, s47, 16384
    buffer_load_dwordx4 v9, s[40:43], s69 offen lds
    s_add_u32 m0, s68, 68608
    s_add_u32 s69, s46, 43008
    buffer_load_dwordx4 v8, s[36:39], s69 offen lds
    s_add_u32 m0, s68, 84992
    s_add_u32 s69, s47, 24576
    buffer_load_dwordx4 v10, s[40:43], s69 offen lds
    s_waitcnt vmcnt(29)
    v_readfirstlane_b32 s16, v62
    v_lshlrev_b32 v208, 16, v32
    v_and_b32 v209, 0xffff0000, v32
    v_lshlrev_b32 v210, 16, v33
    v_and_b32 v211, 0xffff0000, v33
    v_lshlrev_b32 v212, 16, v34
    v_and_b32 v213, 0xffff0000, v34
    v_lshlrev_b32 v214, 16, v35
    v_and_b32 v215, 0xffff0000, v35
    v_lshlrev_b32 v216, 16, v36
    v_and_b32 v217, 0xffff0000, v36
    v_lshlrev_b32 v218, 16, v37
    v_and_b32 v219, 0xffff0000, v37
    v_lshlrev_b32 v220, 16, v38
    v_and_b32 v221, 0xffff0000, v38
    v_lshlrev_b32 v222, 16, v39
    v_and_b32 v223, 0xffff0000, v39
    s_add_u32 s16, s16, 2654435769
    v_add_f32 v224, v208, v209
    v_add_f32 v225, v216, v217
    v_add_f32 v224, v224, v210
    v_add_f32 v225, v225, v218
    v_add_f32 v224, v224, v211
    v_add_f32 v225, v225, v219
    v_add_f32 v224, v224, v212
    v_add_f32 v225, v225, v220
    v_add_f32 v224, v224, v213
    v_add_f32 v225, v225, v221
    v_add_f32 v224, v224, v214
    v_add_f32 v225, v225, v222
    v_add_f32 v224, v224, v215
    v_add_f32 v225, v225, v223
    s_nop 0
    v_add_f32_dpp v224, v224, v224 quad_perm:[1,0,3,2] row_mask:0xf bank_mask:0xf
    v_add_f32_dpp v225, v225, v225 quad_perm:[1,0,3,2] row_mask:0xf bank_mask:0xf
    s_nop 0
    v_add_f32_dpp v224, v224, v224 quad_perm:[2,3,0,1] row_mask:0xf bank_mask:0xf
    v_add_f32_dpp v225, v225, v225 quad_perm:[2,3,0,1] row_mask:0xf bank_mask:0xf
    s_nop 0
    v_add_f32_dpp v224, v224, v224 row_half_mirror row_mask:0xf bank_mask:0xf
    v_add_f32_dpp v225, v225, v225 row_half_mirror row_mask:0xf bank_mask:0xf
    s_nop 0
    v_add_f32_dpp v224, v224, v224 row_mirror row_mask:0xf bank_mask:0xf
    v_add_f32_dpp v225, v225, v225 row_mirror row_mask:0xf bank_mask:0xf
    v_mov_b32 v226, v224
    v_mov_b32 v227, v225
    s_nop 0
    v_permlane16_swap_b32 v224, v226
    v_permlane16_swap_b32 v225, v227
    v_add_f32 v224, v224, v226
    v_add_f32 v225, v225, v227
    v_mov_b32 v226, v224
    v_mov_b32 v227, v225
    s_nop 0
    v_permlane32_swap_b32 v224, v226
    v_permlane32_swap_b32 v225, v227
    v_add_f32 v224, v224, v226
    v_add_f32 v225, v225, v227
    v_mul_f32 v224, 0x3b000000, v224
    v_mul_f32 v225, 0x3b000000, v225
    v_sub_f32 v208, v208, v224
    v_sub_f32 v216, v216, v225
    v_sub_f32 v209, v209, v224
    v_sub_f32 v217, v217, v225
    v_sub_f32 v210, v210, v224
    v_sub_f32 v218, v218, v225
    v_sub_f32 v211, v211, v224
    v_sub_f32 v219, v219, v225
    v_sub_f32 v212, v212, v224
    v_sub_f32 v220, v220, v225
    v_sub_f32 v213, v213, v224
    v_sub_f32 v221, v221, v225
    v_sub_f32 v214, v214, v224
    v_sub_f32 v222, v222, v225
    v_sub_f32 v215, v215, v224
    v_sub_f32 v223, v223, v225
    v_mul_f32 v228, v208, v208
    v_mul_f32 v229, v216, v216
    v_fmac_f32 v228, v209, v209
    v_fmac_f32 v229, v217, v217
    v_fmac_f32 v228, v210, v210
    v_fmac_f32 v229, v218, v218
    v_fmac_f32 v228, v211, v211
    v_fmac_f32 v229, v219, v219
    v_fmac_f32 v228, v212, v212
    v_fmac_f32 v229, v220, v220
    v_fmac_f32 v228, v213, v213
    v_fmac_f32 v229, v221, v221
    v_fmac_f32 v228, v214, v214
    v_fmac_f32 v229, v222, v222
    v_fmac_f32 v228, v215, v215
    v_fmac_f32 v229, v223, v223
    s_nop 0
    v_add_f32_dpp v228, v228, v228 quad_perm:[1,0,3,2] row_mask:0xf bank_mask:0xf
    v_add_f32_dpp v229, v229, v229 quad_perm:[1,0,3,2] row_mask:0xf bank_mask:0xf
    s_nop 0
    v_add_f32_dpp v228, v228, v228 quad_perm:[2,3,0,1] row_mask:0xf bank_mask:0xf
    v_add_f32_dpp v229, v229, v229 quad_perm:[2,3,0,1] row_mask:0xf bank_mask:0xf
    s_nop 0
    v_add_f32_dpp v228, v228, v228 row_half_mirror row_mask:0xf bank_mask:0xf
    v_add_f32_dpp v229, v229, v229 row_half_mirror row_mask:0xf bank_mask:0xf
    s_nop 0
    v_add_f32_dpp v228, v228, v228 row_mirror row_mask:0xf bank_mask:0xf
    v_add_f32_dpp v229, v229, v229 row_mirror row_mask:0xf bank_mask:0xf
    v_mov_b32 v226, v228
    v_mov_b32 v227, v229
    s_nop 0
    v_permlane16_swap_b32 v228, v226
    v_permlane16_swap_b32 v229, v227
    v_add_f32 v228, v228, v226
    v_add_f32 v229, v229, v227
    v_mov_b32 v226, v228
    v_mov_b32 v227, v229
    s_nop 0
    v_permlane32_swap_b32 v228, v226
    v_permlane32_swap_b32 v229, v227
    v_add_f32 v228, v228, v226
    v_add_f32 v229, v229, v227
    v_mul_f32 v228, 0x3b000000, v228
    v_mul_f32 v229, 0x3b000000, v229
    v_and_b32 v226, 1, v1
    v_cmp_eq_u32 vcc, 1, v226
    s_nop 1
    v_cndmask_b32 v224, v224, v225, vcc
    v_cndmask_b32 v228, v228, v229, vcc
    v_cvt_pk_bf16_f32 v232, v224, v228
    v_and_b32 v227, 0xffff0000, v232
    v_add_f32 v227, 0x3727c5ac, v227
    v_cvt_pk_bf16_f32 v227, v227, v227
    v_lshlrev_b32 v227, 16, v227
    v_sqrt_f32 v227, v227
    s_nop 0
    v_cvt_pk_bf16_f32 v227, v227, v227
    v_and_b32 v232, 0xffff, v232
    v_and_b32 v227, 0xffff0000, v227
    v_or_b32 v232, v232, v227
    v_mov_b32 v233, s16
    v_mov_b32 v60, v232
    v_mov_b32 v61, v233
    s_add_u32 s46, s65, 3
    s_and_b32 s46, s46, 7
    s_lshl_b32 s47, s46, 7
    s_add_u32 s47, s47, s67
    s_mul_i32 s46, s46, 229376
    s_add_u32 s46, s46, s66
    s_add_u32 m0, s68, 98304
    s_add_u32 s69, s46, 0
    buffer_load_dwordx4 v8, s[36:39], s69 offen lds
    s_add_u32 m0, s68, 114688
    s_add_u32 s69, s47, 0
    buffer_load_dwordx4 v9, s[40:43], s69 offen lds
    s_add_u32 m0, s68, 99328
    s_add_u32 s69, s46, 14336
    buffer_load_dwordx4 v8, s[36:39], s69 offen lds
    s_add_u32 m0, s68, 115712
    s_add_u32 s69, s47, 8192
    buffer_load_dwordx4 v10, s[40:43], s69 offen lds
    s_add_u32 m0, s68, 100352
    s_add_u32 s69, s46, 28672
    buffer_load_dwordx4 v8, s[36:39], s69 offen lds
    s_add_u32 m0, s68, 116736
    s_add_u32 s69, s47, 16384
    buffer_load_dwordx4 v9, s[40:43], s69 offen lds
    s_add_u32 m0, s68, 101376
    s_add_u32 s69, s46, 43008
    buffer_load_dwordx4 v8, s[36:39], s69 offen lds
    s_add_u32 m0, s68, 117760
    s_add_u32 s69, s47, 24576
    buffer_load_dwordx4 v10, s[40:43], s69 offen lds
    s_waitcnt vmcnt(32)
    s_barrier
    v_lshrrev_b32 v42, 4, v1
    v_lshlrev_b32 v42, 3, v42
    v_bfe_u32 v43, v1, 2, 2
    v_add_u32 v42, v42, v43
    v_lshlrev_b32 v42, 7, v42
    v_and_b32 v43, 3, v1
    v_lshl_add_u32 v42, v43, 3, v42
    s_lshl_b32 s59, s3, 5
    v_add_u32 v42, s59, v42
    v_add_u32 v43, 131072, v42
    v_add_u32 v44, 140288, v42
    ds_read_b64_tr_b16 v[188:189], v43 offset:512
    ds_read_b64_tr_b16 v[190:191], v43 offset:1024
    ds_read_b64_tr_b16 v[192:193], v43 offset:1536
    ds_read_b64_tr_b16 v[200:201], v44 offset:0
    ds_read_b64_tr_b16 v[202:203], v44 offset:512
    ds_read_b64_tr_b16 v[194:195], v43 offset:4608
    ds_read_b64_tr_b16 v[196:197], v43 offset:5120
    ds_read_b64_tr_b16 v[198:199], v43 offset:5632
    ds_read_b64_tr_b16 v[204:205], v44 offset:4096
    ds_read_b64_tr_b16 v[206:207], v44 offset:4608
    v_lshlrev_b32 v54, 16, v40
    v_and_b32 v55, 0xffff0000, v40
    v_lshlrev_b32 v56, 16, v41
    v_and_b32 v57, 0xffff0000, v41
    v_lshlrev_b32 v42, 12, v58
    v_lshrrev_b32 v43, 4, v1
    v_lshl_add_u32 v42, v43, 4, v42
    s_lshl_b32 s57, s48, 1
    s_add_u32 s57, s57, 0
    s_waitcnt lgkmcnt(5)
    v_and_b32 v209, 0xffff0000, v188
    v_lshlrev_b32 v210, 16, v189
    v_and_b32 v211, 0xffff0000, v189
    v_lshlrev_b32 v212, 16, v190
    v_and_b32 v213, 0xffff0000, v190
    v_lshlrev_b32 v214, 16, v191
    v_and_b32 v215, 0xffff0000, v191
    v_lshlrev_b32 v216, 16, v192
    v_and_b32 v217, 0xffff0000, v192
    v_lshlrev_b32 v218, 16, v193
    v_and_b32 v219, 0xffff0000, v193
    v_lshlrev_b32 v220, 16, v200
    v_and_b32 v221, 0xffff0000, v200
    v_lshlrev_b32 v222, 16, v201
    v_and_b32 v223, 0xffff0000, v201
    v_lshlrev_b32 v224, 16, v202
    v_and_b32 v225, 0xffff0000, v202
    v_lshlrev_b32 v226, 16, v203
    v_and_b32 v227, 0xffff0000, v203
    v_mul_f32 v228, v209, v57
    v_mul_f32 v229, v210, v57
    v_mul_f32 v230, v211, v57
    v_mul_f32 v231, v212, v57
    v_mul_f32 v232, v213, v57
    v_mul_f32 v233, v214, v57
    v_mul_f32 v234, v215, v57
    v_mul_f32 v235, v216, v57
    v_fmac_f32 v228, v210, v56
    v_fmac_f32 v229, v211, v56
    v_fmac_f32 v230, v212, v56
    v_fmac_f32 v231, v213, v56
    v_fmac_f32 v232, v214, v56
    v_fmac_f32 v233, v215, v56
    v_fmac_f32 v234, v216, v56
    v_fmac_f32 v235, v217, v56
    v_fmac_f32 v228, v211, v55
    v_fmac_f32 v229, v212, v55
    v_fmac_f32 v230, v213, v55
    v_fmac_f32 v231, v214, v55
    v_fmac_f32 v232, v215, v55
    v_fmac_f32 v233, v216, v55
    v_fmac_f32 v234, v217, v55
    v_fmac_f32 v235, v218, v55
    v_fmac_f32 v228, v212, v54
    v_fmac_f32 v229, v213, v54
    v_fmac_f32 v230, v214, v54
    v_fmac_f32 v231, v215, v54
    v_fmac_f32 v232, v216, v54
    v_fmac_f32 v233, v217, v54
    v_fmac_f32 v234, v218, v54
    v_fmac_f32 v235, v219, v54
    v_mul_f32 v228, v228, v220
    v_mul_f32 v229, v229, v221
    v_mul_f32 v230, v230, v222
    v_mul_f32 v231, v231, v223
    v_mul_f32 v232, v232, v224
    v_mul_f32 v233, v233, v225
    v_mul_f32 v234, v234, v226
    v_mul_f32 v235, v235, v227
    v_cvt_pk_bf16_f32 v236, v228, v229
    v_cvt_pk_bf16_f32 v237, v230, v231
    v_cvt_pk_bf16_f32 v238, v232, v233
    v_cvt_pk_bf16_f32 v239, v234, v235
    s_waitcnt lgkmcnt(0)
    v_and_b32 v209, 0xffff0000, v194
    v_lshlrev_b32 v210, 16, v195
    v_and_b32 v211, 0xffff0000, v195
    v_lshlrev_b32 v212, 16, v196
    v_and_b32 v213, 0xffff0000, v196
    v_lshlrev_b32 v214, 16, v197
    v_and_b32 v215, 0xffff0000, v197
    v_lshlrev_b32 v216, 16, v198
    v_and_b32 v217, 0xffff0000, v198
    v_lshlrev_b32 v218, 16, v199
    v_and_b32 v219, 0xffff0000, v199
    v_lshlrev_b32 v220, 16, v204
    v_and_b32 v221, 0xffff0000, v204
    v_lshlrev_b32 v222, 16, v205
    v_and_b32 v223, 0xffff0000, v205
    v_lshlrev_b32 v224, 16, v206
    v_and_b32 v225, 0xffff0000, v206
    v_lshlrev_b32 v226, 16, v207
    v_and_b32 v227, 0xffff0000, v207
    v_mul_f32 v228, v209, v57
    v_mul_f32 v229, v210, v57
    v_mul_f32 v230, v211, v57
    v_mul_f32 v231, v212, v57
    v_mul_f32 v232, v213, v57
    v_mul_f32 v233, v214, v57
    v_mul_f32 v234, v215, v57
    v_mul_f32 v235, v216, v57
    v_fmac_f32 v228, v210, v56
    v_fmac_f32 v229, v211, v56
    v_fmac_f32 v230, v212, v56
    v_fmac_f32 v231, v213, v56
    v_fmac_f32 v232, v214, v56
    v_fmac_f32 v233, v215, v56
    v_fmac_f32 v234, v216, v56
    v_fmac_f32 v235, v217, v56
    v_fmac_f32 v228, v211, v55
    v_fmac_f32 v229, v212, v55
    v_fmac_f32 v230, v213, v55
    v_fmac_f32 v231, v214, v55
    v_fmac_f32 v232, v215, v55
    v_fmac_f32 v233, v216, v55
    v_fmac_f32 v234, v217, v55
    v_fmac_f32 v235, v218, v55
    v_fmac_f32 v228, v212, v54
    v_fmac_f32 v229, v213, v54
    v_fmac_f32 v230, v214, v54
    v_fmac_f32 v231, v215, v54
    v_fmac_f32 v232, v216, v54
    v_fmac_f32 v233, v217, v54
    v_fmac_f32 v234, v218, v54
    v_fmac_f32 v235, v219, v54
    v_mul_f32 v228, v228, v220
    v_mul_f32 v229, v229, v221
    v_mul_f32 v230, v230, v222
    v_mul_f32 v231, v231, v223
    v_mul_f32 v232, v232, v224
    v_mul_f32 v233, v233, v225
    v_mul_f32 v234, v234, v226
    v_mul_f32 v235, v235, v227
    v_cvt_pk_bf16_f32 v240, v228, v229
    v_cvt_pk_bf16_f32 v241, v230, v231
    v_cvt_pk_bf16_f32 v242, v232, v233
    v_cvt_pk_bf16_f32 v243, v234, v235
    buffer_store_dwordx4 v[236:239], v42, s[32:35], s57 offen offset:0 sc1
    buffer_store_dwordx4 v[240:243], v42, s[32:35], s57 offen offset:64 sc1
    s_lshl_b32 s59, s58, 6
    s_add_u32 s59, s59, 15204352
    v_lshlrev_b32 v59, 3, v1
    s_mov_b64 exec, 3
    buffer_store_dwordx2 v[60:61], v59, s[32:35], s59 offen sc1
    s_mov_b64 exec, -1
    s_mov_b32 s99, 0
    s_waitcnt vmcnt(27)
    s_barrier
    ds_read_b64_tr_b16 v[128:129], v12 offset:0
    ds_read_b64_tr_b16 v[130:131], v12 offset:1024
    ds_read_b128 v[136:139], v16 offset:0
    ds_read_b128 v[140:143], v16 offset:4096
    ds_read_b64_tr_b16 v[132:133], v14 offset:0
    ds_read_b64_tr_b16 v[134:135], v14 offset:1024
    s_waitcnt lgkmcnt(3)
    v_mfma_f32_32x32x16_bf16 v[64:79], v[128:131], v[136:139], v[64:79]
    ds_read_b64_tr_b16 v[144:145], v12 offset:4096
    ds_read_b64_tr_b16 v[146:147], v12 offset:5120
    s_waitcnt lgkmcnt(4)
    v_mfma_f32_32x32x16_bf16 v[80:95], v[128:131], v[140:143], v[80:95]
    ds_read_b128 v[152:155], v18 offset:0
    ds_read_b128 v[156:159], v18 offset:4096
    s_mov_b32 s92, s12
    s_mov_b32 s93, s13
    s_mov_b32 s94, 0x200000
    s_mov_b32 s95, 0x20000
    buffer_load_dwordx4 a[224:227], v244, s[92:95], 0 offen
    v_mfma_f32_16x16x32_bf16 v[160:163], v[128:131], v[168:171], v[160:163]
    s_waitcnt lgkmcnt(4)
    v_mfma_f32_32x32x16_bf16 v[96:111], v[132:135], v[136:139], v[96:111]
    ds_read_b64_tr_b16 v[148:149], v14 offset:4096
    ds_read_b64_tr_b16 v[150:151], v14 offset:5120
    v_mfma_f32_32x32x16_bf16 v[112:127], v[132:135], v[140:143], v[112:127]
    buffer_load_dwordx2 a[228:229], v245, s[92:95], 0 offen
    s_waitcnt lgkmcnt(3)
    v_mfma_f32_32x32x16_bf16 v[64:79], v[144:147], v[152:155], v[64:79]
    ds_read_b64_tr_b16 v[128:129], v12 offset:8192
    ds_read_b64_tr_b16 v[130:131], v12 offset:9216
    buffer_load_dwordx4 a[232:235], v246, s[92:95], 0 offen
    s_waitcnt lgkmcnt(4)
    v_mfma_f32_32x32x16_bf16 v[80:95], v[144:147], v[156:159], v[80:95]
    ds_read_b128 v[136:139], v20 offset:0
    ds_read_b128 v[140:143], v20 offset:4096
    buffer_load_dwordx2 a[230:231], v247, s[92:95], 0 offen
    v_mfma_f32_16x16x32_bf16 v[160:163], v[144:147], v[168:171], v[160:163]
    s_waitcnt lgkmcnt(4)
    v_mfma_f32_32x32x16_bf16 v[96:111], v[148:151], v[152:155], v[96:111]
    ds_read_b64_tr_b16 v[132:133], v14 offset:8192
    ds_read_b64_tr_b16 v[134:135], v14 offset:9216
    v_mfma_f32_32x32x16_bf16 v[112:127], v[148:151], v[156:159], v[112:127]
    s_mov_b32 s92, s24
    s_mov_b32 s93, s25
    s_mov_b32 s94, 0x400
    s_mov_b32 s95, 0x20000
    v_lshlrev_b32 v244, 7, v1
    buffer_load_dword v248, v244, s[92:95], 0 offen
    s_waitcnt lgkmcnt(3)
    v_mfma_f32_32x32x16_bf16 v[64:79], v[128:131], v[136:139], v[64:79]
    ds_read_b64_tr_b16 v[144:145], v12 offset:12288
    ds_read_b64_tr_b16 v[146:147], v12 offset:13312
    s_waitcnt lgkmcnt(4)
    v_mfma_f32_32x32x16_bf16 v[80:95], v[128:131], v[140:143], v[80:95]
    ds_read_b128 v[152:155], v22 offset:0
    ds_read_b128 v[156:159], v22 offset:4096
    v_mfma_f32_16x16x32_bf16 v[160:163], v[128:131], v[168:171], v[160:163]
    s_waitcnt lgkmcnt(4)
    v_mfma_f32_32x32x16_bf16 v[96:111], v[132:135], v[136:139], v[96:111]
    ds_read_b64_tr_b16 v[148:149], v14 offset:12288
    ds_read_b64_tr_b16 v[150:151], v14 offset:13312
    s_mov_b32 s92, s20
    s_mov_b32 s93, s21
    s_mov_b32 s94, 0xe00
    s_mov_b32 s95, 0x20000
    s_mov_b32 m0, 156672
    s_nop 0
    buffer_load_dwordx4 v252, s[92:95], 0 offen lds
    v_mfma_f32_32x32x16_bf16 v[112:127], v[132:135], v[140:143], v[112:127]
    s_waitcnt vmcnt(25)
    s_waitcnt lgkmcnt(0)
    s_barrier
    v_mfma_f32_32x32x16_bf16 v[64:79], v[144:147], v[152:155], v[64:79]
    ds_read_b64_tr_b16 v[128:129], v12 offset:32768
    ds_read_b64_tr_b16 v[130:131], v12 offset:33792
    v_mfma_f32_32x32x16_bf16 v[80:95], v[144:147], v[156:159], v[80:95]
    ds_read_b128 v[136:139], v16 offset:32768
    ds_read_b128 v[140:143], v16 offset:36864
    s_add_u32 s46, s65, 4
    s_and_b32 s46, s46, 7
    s_lshl_b32 s47, s46, 7
    s_add_u32 s47, s47, s67
    s_mul_i32 s46, s46, 229376
    s_add_u32 s46, s46, s66
    s_add_u32 m0, s68, 0
    s_add_u32 s69, s46, 0
    buffer_load_dwordx4 v8, s[36:39], s69 offen lds
    v_mfma_f32_16x16x32_bf16 v[160:163], v[144:147], v[168:171], v[160:163]
    v_mfma_f32_32x32x16_bf16 v[96:111], v[148:151], v[152:155], v[96:111]
    ds_read_b64_tr_b16 v[132:133], v14 offset:32768
    ds_read_b64_tr_b16 v[134:135], v14 offset:33792
    v_mfma_f32_32x32x16_bf16 v[112:127], v[148:151], v[156:159], v[112:127]
    s_waitcnt lgkmcnt(3)
    v_mfma_f32_32x32x16_bf16 v[64:79], v[128:131], v[136:139], v[64:79]
    ds_read_b64_tr_b16 v[144:145], v12 offset:36864
    ds_read_b64_tr_b16 v[146:147], v12 offset:37888
    s_add_u32 m0, s68, 16384
    s_add_u32 s69, s47, 0
    buffer_load_dwordx4 v9, s[40:43], s69 offen lds
    s_waitcnt lgkmcnt(4)
    v_mfma_f32_32x32x16_bf16 v[80:95], v[128:131], v[140:143], v[80:95]
    ds_read_b128 v[152:155], v18 offset:32768
    ds_read_b128 v[156:159], v18 offset:36864
    v_mfma_f32_16x16x32_bf16 v[160:163], v[128:131], v[168:171], v[160:163]
    s_waitcnt lgkmcnt(4)
    v_mfma_f32_32x32x16_bf16 v[96:111], v[132:135], v[136:139], v[96:111]
    ds_read_b64_tr_b16 v[148:149], v14 offset:36864
    ds_read_b64_tr_b16 v[150:151], v14 offset:37888
    s_add_u32 m0, s68, 1024
    s_add_u32 s69, s46, 14336
    buffer_load_dwordx4 v8, s[36:39], s69 offen lds
    v_mfma_f32_32x32x16_bf16 v[112:127], v[132:135], v[140:143], v[112:127]
    s_waitcnt lgkmcnt(3)
    v_mfma_f32_32x32x16_bf16 v[64:79], v[144:147], v[152:155], v[64:79]
    ds_read_b64_tr_b16 v[128:129], v12 offset:40960
    ds_read_b64_tr_b16 v[130:131], v12 offset:41984
    s_add_u32 m0, s68, 17408
    s_add_u32 s69, s47, 8192
    buffer_load_dwordx4 v10, s[40:43], s69 offen lds
    s_waitcnt lgkmcnt(4)
    v_mfma_f32_32x32x16_bf16 v[80:95], v[144:147], v[156:159], v[80:95]
    ds_read_b128 v[136:139], v20 offset:32768
    ds_read_b128 v[140:143], v20 offset:36864
    s_add_u32 m0, s68, 2048
    s_add_u32 s69, s46, 28672
    buffer_load_dwordx4 v8, s[36:39], s69 offen lds
    v_mfma_f32_16x16x32_bf16 v[160:163], v[144:147], v[168:171], v[160:163]
    s_waitcnt lgkmcnt(4)
    v_mfma_f32_32x32x16_bf16 v[96:111], v[148:151], v[152:155], v[96:111]
    ds_read_b64_tr_b16 v[132:133], v14 offset:40960
    ds_read_b64_tr_b16 v[134:135], v14 offset:41984
    v_mfma_f32_32x32x16_bf16 v[112:127], v[148:151], v[156:159], v[112:127]
    s_add_u32 m0, s68, 18432
    s_add_u32 s69, s47, 16384
    buffer_load_dwordx4 v9, s[40:43], s69 offen lds
    s_waitcnt lgkmcnt(3)
    v_mfma_f32_32x32x16_bf16 v[64:79], v[128:131], v[136:139], v[64:79]
    ds_read_b64_tr_b16 v[144:145], v12 offset:45056
    ds_read_b64_tr_b16 v[146:147], v12 offset:46080
    s_waitcnt lgkmcnt(4)
    v_mfma_f32_32x32x16_bf16 v[80:95], v[128:131], v[140:143], v[80:95]
    ds_read_b128 v[152:155], v22 offset:32768
    ds_read_b128 v[156:159], v22 offset:36864
    s_add_u32 m0, s68, 3072
    s_add_u32 s69, s46, 43008
    buffer_load_dwordx4 v8, s[36:39], s69 offen lds
    v_mfma_f32_16x16x32_bf16 v[160:163], v[128:131], v[168:171], v[160:163]
    s_waitcnt lgkmcnt(4)
    v_mfma_f32_32x32x16_bf16 v[96:111], v[132:135], v[136:139], v[96:111]
    ds_read_b64_tr_b16 v[148:149], v14 offset:45056
    ds_read_b64_tr_b16 v[150:151], v14 offset:46080
    v_mfma_f32_32x32x16_bf16 v[112:127], v[132:135], v[140:143], v[112:127]
    s_add_u32 m0, s68, 19456
    s_add_u32 s69, s47, 24576
    buffer_load_dwordx4 v10, s[40:43], s69 offen lds
    s_waitcnt vmcnt(25)
    s_waitcnt lgkmcnt(0)
    s_barrier
    v_mfma_f32_32x32x16_bf16 v[64:79], v[144:147], v[152:155], v[64:79]
    ds_read_b64_tr_b16 v[128:129], v13 offset:0
    ds_read_b64_tr_b16 v[130:131], v13 offset:1024
    v_mfma_f32_32x32x16_bf16 v[80:95], v[144:147], v[156:159], v[80:95]
    ds_read_b128 v[136:139], v17 offset:0
    ds_read_b128 v[140:143], v17 offset:4096
    s_add_u32 s46, s65, 5
    s_and_b32 s46, s46, 7
    s_lshl_b32 s47, s46, 7
    s_add_u32 s47, s47, s67
    s_mul_i32 s46, s46, 229376
    s_add_u32 s46, s46, s66
    s_add_u32 m0, s68, 32768
    s_add_u32 s69, s46, 0
    buffer_load_dwordx4 v8, s[36:39], s69 offen lds
    v_mfma_f32_16x16x32_bf16 v[160:163], v[144:147], v[168:171], v[160:163]
    v_mfma_f32_32x32x16_bf16 v[96:111], v[148:151], v[152:155], v[96:111]
    ds_read_b64_tr_b16 v[132:133], v15 offset:0
    ds_read_b64_tr_b16 v[134:135], v15 offset:1024
    v_mfma_f32_32x32x16_bf16 v[112:127], v[148:151], v[156:159], v[112:127]
    s_waitcnt lgkmcnt(3)
    v_mfma_f32_32x32x16_bf16 v[64:79], v[128:131], v[136:139], v[64:79]
    ds_read_b64_tr_b16 v[144:145], v13 offset:4096
    ds_read_b64_tr_b16 v[146:147], v13 offset:5120
    s_add_u32 m0, s68, 49152
    s_add_u32 s69, s47, 0
    buffer_load_dwordx4 v9, s[40:43], s69 offen lds
    s_waitcnt lgkmcnt(4)
    v_mfma_f32_32x32x16_bf16 v[80:95], v[128:131], v[140:143], v[80:95]
    ds_read_b128 v[152:155], v19 offset:0
    ds_read_b128 v[156:159], v19 offset:4096
    v_mfma_f32_16x16x32_bf16 v[160:163], v[128:131], v[168:171], v[160:163]
    s_waitcnt lgkmcnt(4)
    v_mfma_f32_32x32x16_bf16 v[96:111], v[132:135], v[136:139], v[96:111]
    ds_read_b64_tr_b16 v[148:149], v15 offset:4096
    ds_read_b64_tr_b16 v[150:151], v15 offset:5120
    s_add_u32 m0, s68, 33792
    s_add_u32 s69, s46, 14336
    buffer_load_dwordx4 v8, s[36:39], s69 offen lds
    v_mfma_f32_32x32x16_bf16 v[112:127], v[132:135], v[140:143], v[112:127]
    s_waitcnt lgkmcnt(3)
    v_mfma_f32_32x32x16_bf16 v[64:79], v[144:147], v[152:155], v[64:79]
    ds_read_b64_tr_b16 v[128:129], v13 offset:8192
    ds_read_b64_tr_b16 v[130:131], v13 offset:9216
    s_add_u32 m0, s68, 50176
    s_add_u32 s69, s47, 8192
    buffer_load_dwordx4 v10, s[40:43], s69 offen lds
    s_waitcnt lgkmcnt(4)
    v_mfma_f32_32x32x16_bf16 v[80:95], v[144:147], v[156:159], v[80:95]
    ds_read_b128 v[136:139], v21 offset:0
    ds_read_b128 v[140:143], v21 offset:4096
    s_add_u32 m0, s68, 34816
    s_add_u32 s69, s46, 28672
    buffer_load_dwordx4 v8, s[36:39], s69 offen lds
    v_mfma_f32_16x16x32_bf16 v[160:163], v[144:147], v[168:171], v[160:163]
    s_waitcnt lgkmcnt(4)
    v_mfma_f32_32x32x16_bf16 v[96:111], v[148:151], v[152:155], v[96:111]
    ds_read_b64_tr_b16 v[132:133], v15 offset:8192
    ds_read_b64_tr_b16 v[134:135], v15 offset:9216
    v_mfma_f32_32x32x16_bf16 v[112:127], v[148:151], v[156:159], v[112:127]
    s_add_u32 m0, s68, 51200
    s_add_u32 s69, s47, 16384
    buffer_load_dwordx4 v9, s[40:43], s69 offen lds
    s_waitcnt lgkmcnt(3)
    v_mfma_f32_32x32x16_bf16 v[64:79], v[128:131], v[136:139], v[64:79]
    ds_read_b64_tr_b16 v[144:145], v13 offset:12288
    ds_read_b64_tr_b16 v[146:147], v13 offset:13312
    s_waitcnt lgkmcnt(4)
    v_mfma_f32_32x32x16_bf16 v[80:95], v[128:131], v[140:143], v[80:95]
    ds_read_b128 v[152:155], v23 offset:0
    ds_read_b128 v[156:159], v23 offset:4096
    s_add_u32 m0, s68, 35840
    s_add_u32 s69, s46, 43008
    buffer_load_dwordx4 v8, s[36:39], s69 offen lds
    v_mfma_f32_16x16x32_bf16 v[160:163], v[128:131], v[168:171], v[160:163]
    s_waitcnt lgkmcnt(4)
    v_mfma_f32_32x32x16_bf16 v[96:111], v[132:135], v[136:139], v[96:111]
    ds_read_b64_tr_b16 v[148:149], v15 offset:12288
    ds_read_b64_tr_b16 v[150:151], v15 offset:13312
    v_mfma_f32_32x32x16_bf16 v[112:127], v[132:135], v[140:143], v[112:127]
    s_add_u32 m0, s68, 52224
    s_add_u32 s69, s47, 24576
    buffer_load_dwordx4 v10, s[40:43], s69 offen lds
    s_waitcnt vmcnt(25)
    s_waitcnt lgkmcnt(0)
    s_barrier
    v_mfma_f32_32x32x16_bf16 v[64:79], v[144:147], v[152:155], v[64:79]
    ds_read_b64_tr_b16 v[128:129], v13 offset:32768
    ds_read_b64_tr_b16 v[130:131], v13 offset:33792
    v_mfma_f32_32x32x16_bf16 v[80:95], v[144:147], v[156:159], v[80:95]
    ds_read_b128 v[136:139], v17 offset:32768
    ds_read_b128 v[140:143], v17 offset:36864
    s_add_u32 s46, s65, 6
    s_and_b32 s46, s46, 7
    s_lshl_b32 s47, s46, 7
    s_add_u32 s47, s47, s67
    s_mul_i32 s46, s46, 229376
    s_add_u32 s46, s46, s66
    s_add_u32 m0, s68, 65536
    s_add_u32 s69, s46, 0
    buffer_load_dwordx4 v8, s[36:39], s69 offen lds
    v_mfma_f32_16x16x32_bf16 v[160:163], v[144:147], v[168:171], v[160:163]
    v_mfma_f32_32x32x16_bf16 v[96:111], v[148:151], v[152:155], v[96:111]
    ds_read_b64_tr_b16 v[132:133], v15 offset:32768
    ds_read_b64_tr_b16 v[134:135], v15 offset:33792
    v_mfma_f32_32x32x16_bf16 v[112:127], v[148:151], v[156:159], v[112:127]
    s_add_u32 m0, s68, 81920
    s_add_u32 s69, s47, 0
    buffer_load_dwordx4 v9, s[40:43], s69 offen lds
    s_waitcnt lgkmcnt(3)
    v_mfma_f32_32x32x16_bf16 v[64:79], v[128:131], v[136:139], v[64:79]
    ds_read_b64_tr_b16 v[144:145], v13 offset:36864
    ds_read_b64_tr_b16 v[146:147], v13 offset:37888
    s_waitcnt lgkmcnt(4)
    v_mfma_f32_32x32x16_bf16 v[80:95], v[128:131], v[140:143], v[80:95]
    ds_read_b128 v[152:155], v19 offset:32768
    ds_read_b128 v[156:159], v19 offset:36864
    s_add_u32 m0, s68, 66560
    s_add_u32 s69, s46, 14336
    buffer_load_dwordx4 v8, s[36:39], s69 offen lds
    v_mfma_f32_16x16x32_bf16 v[160:163], v[128:131], v[168:171], v[160:163]
    s_waitcnt lgkmcnt(4)
    v_mfma_f32_32x32x16_bf16 v[96:111], v[132:135], v[136:139], v[96:111]
    ds_read_b64_tr_b16 v[148:149], v15 offset:36864
    ds_read_b64_tr_b16 v[150:151], v15 offset:37888
    s_add_u32 m0, s68, 82944
    s_add_u32 s69, s47, 8192
    buffer_load_dwordx4 v10, s[40:43], s69 offen lds
    v_mfma_f32_32x32x16_bf16 v[112:127], v[132:135], v[140:143], v[112:127]
    s_add_u32 m0, s68, 67584
    s_add_u32 s69, s46, 28672
    buffer_load_dwordx4 v8, s[36:39], s69 offen lds
    s_waitcnt lgkmcnt(3)
    v_mfma_f32_32x32x16_bf16 v[64:79], v[144:147], v[152:155], v[64:79]
    ds_read_b64_tr_b16 v[128:129], v13 offset:40960
    ds_read_b64_tr_b16 v[130:131], v13 offset:41984
    s_waitcnt lgkmcnt(4)
    v_mfma_f32_32x32x16_bf16 v[80:95], v[144:147], v[156:159], v[80:95]
    ds_read_b128 v[136:139], v21 offset:32768
    ds_read_b128 v[140:143], v21 offset:36864
    s_add_u32 m0, s68, 83968
    s_add_u32 s69, s47, 16384
    buffer_load_dwordx4 v9, s[40:43], s69 offen lds
    v_mfma_f32_16x16x32_bf16 v[160:163], v[144:147], v[168:171], v[160:163]
    s_waitcnt lgkmcnt(4)
    v_mfma_f32_32x32x16_bf16 v[96:111], v[148:151], v[152:155], v[96:111]
    ds_read_b64_tr_b16 v[132:133], v15 offset:40960
    ds_read_b64_tr_b16 v[134:135], v15 offset:41984
    s_add_u32 m0, s68, 68608
    s_add_u32 s69, s46, 43008
    buffer_load_dwordx4 v8, s[36:39], s69 offen lds
    v_mfma_f32_32x32x16_bf16 v[112:127], v[148:151], v[156:159], v[112:127]
    s_add_u32 m0, s68, 84992
    s_add_u32 s69, s47, 24576
    buffer_load_dwordx4 v10, s[40:43], s69 offen lds
    s_waitcnt lgkmcnt(3)
    v_mfma_f32_32x32x16_bf16 v[64:79], v[128:131], v[136:139], v[64:79]
    ds_read_b64_tr_b16 v[144:145], v13 offset:45056
    ds_read_b64_tr_b16 v[146:147], v13 offset:46080
    s_waitcnt lgkmcnt(4)
    v_mfma_f32_32x32x16_bf16 v[80:95], v[128:131], v[140:143], v[80:95]
    ds_read_b128 v[152:155], v23 offset:32768
    ds_read_b128 v[156:159], v23 offset:36864
    v_and_b32 v35, 31, v1
    v_lshlrev_b32 v35, 7, v35
    v_add_u32 v35, 14876672, v35
    buffer_load_dword v38, v35, s[32:35], 0 offen sc1
    v_mfma_f32_16x16x32_bf16 v[160:163], v[128:131], v[168:171], v[160:163]
    s_waitcnt lgkmcnt(4)
    v_mfma_f32_32x32x16_bf16 v[96:111], v[132:135], v[136:139], v[96:111]
    ds_read_b64_tr_b16 v[148:149], v15 offset:45056
    ds_read_b64_tr_b16 v[150:151], v15 offset:46080
    v_mfma_f32_32x32x16_bf16 v[112:127], v[132:135], v[140:143], v[112:127]
    s_cmp_lg_u32 s99, 0
    s_cbranch_scc1 Ltq2
    s_getreg_b32 s90, hwreg(HW_REG_IB_STS)
    s_and_b32 s91, s90, 15
    s_lshr_b32 s90, s90, 18
    s_and_b32 s90, s90, 0x30
    s_or_b32 s90, s90, s91
    s_cmp_gt_u32 s90, 31
    s_cbranch_scc1 Ltq2
    s_and_b32 s59, s2, 7
    s_lshl_b32 s59, s59, 2
    s_add_u32 s59, s59, s3
    s_lshl_b32 s59, s59, 5
    s_lshr_b32 s60, s2, 3
    s_add_u32 s59, s59, s60
    s_lshl_b32 s59, s59, 7
    s_add_u32 s59, s59, 14745600
    s_lshl_b32 s53, s2, 7
    s_lshl_b32 s60, s3, 2
    s_add_u32 s53, s53, s60
    s_add_u32 s53, s53, 14893056
    v_mov_b32 v56, 0
    v_writelane_b32 v56, s59, 0
    v_writelane_b32 v56, s53, 1
    v_mov_b32 v57, s16
    s_mov_b64 exec, 3
    buffer_store_dword v57, v56, s[32:35], 0 offen sc1
    s_mov_b64 exec, -1
    s_mov_b32 s99, 1
Ltq2:
    s_waitcnt vmcnt(17)
    s_waitcnt lgkmcnt(0)
    s_barrier
    v_mfma_f32_32x32x16_bf16 v[64:79], v[144:147], v[152:155], v[64:79]
    ds_read_b64_tr_b16 v[128:129], v12 offset:0
    ds_read_b64_tr_b16 v[130:131], v12 offset:1024
    v_mfma_f32_32x32x16_bf16 v[80:95], v[144:147], v[156:159], v[80:95]
    ds_read_b128 v[136:139], v16 offset:0
    ds_read_b128 v[140:143], v16 offset:4096
    s_add_u32 s46, s65, 7
    s_and_b32 s46, s46, 7
    s_lshl_b32 s47, s46, 7
    s_add_u32 s47, s47, s67
    s_mul_i32 s46, s46, 229376
    s_add_u32 s46, s46, s66
    s_add_u32 m0, s68, 98304
    s_add_u32 s69, s46, 0
    buffer_load_dwordx4 v8, s[36:39], s69 offen lds
    v_mfma_f32_16x16x32_bf16 v[160:163], v[144:147], v[168:171], v[160:163]
    v_mfma_f32_32x32x16_bf16 v[96:111], v[148:151], v[152:155], v[96:111]
    ds_read_b64_tr_b16 v[132:133], v14 offset:0
    ds_read_b64_tr_b16 v[134:135], v14 offset:1024
    v_mfma_f32_32x32x16_bf16 v[112:127], v[148:151], v[156:159], v[112:127]
    s_waitcnt lgkmcnt(3)
    v_mfma_f32_32x32x16_bf16 v[64:79], v[128:131], v[136:139], v[64:79]
    ds_read_b64_tr_b16 v[144:145], v12 offset:4096
    ds_read_b64_tr_b16 v[146:147], v12 offset:5120
    s_add_u32 m0, s68, 114688
    s_add_u32 s69, s47, 0
    buffer_load_dwordx4 v9, s[40:43], s69 offen lds
    s_waitcnt lgkmcnt(4)
    v_mfma_f32_32x32x16_bf16 v[80:95], v[128:131], v[140:143], v[80:95]
    ds_read_b128 v[152:155], v18 offset:0
    ds_read_b128 v[156:159], v18 offset:4096
    s_add_u32 m0, s68, 99328
    s_add_u32 s69, s46, 14336
    buffer_load_dwordx4 v8, s[36:39], s69 offen lds
    v_mfma_f32_16x16x32_bf16 v[160:163], v[128:131], v[168:171], v[160:163]
    s_waitcnt lgkmcnt(4)
    v_mfma_f32_32x32x16_bf16 v[96:111], v[132:135], v[136:139], v[96:111]
    ds_read_b64_tr_b16 v[148:149], v14 offset:4096
    ds_read_b64_tr_b16 v[150:151], v14 offset:5120
    v_mfma_f32_32x32x16_bf16 v[112:127], v[132:135], v[140:143], v[112:127]
    s_add_u32 m0, s68, 115712
    s_add_u32 s69, s47, 8192
    buffer_load_dwordx4 v10, s[40:43], s69 offen lds
    s_waitcnt lgkmcnt(3)
    v_mfma_f32_32x32x16_bf16 v[64:79], v[144:147], v[152:155], v[64:79]
    ds_read_b64_tr_b16 v[128:129], v12 offset:8192
    ds_read_b64_tr_b16 v[130:131], v12 offset:9216
    s_add_u32 m0, s68, 100352
    s_add_u32 s69, s46, 28672
    buffer_load_dwordx4 v8, s[36:39], s69 offen lds
    s_waitcnt lgkmcnt(4)
    v_mfma_f32_32x32x16_bf16 v[80:95], v[144:147], v[156:159], v[80:95]
    ds_read_b128 v[136:139], v20 offset:0
    ds_read_b128 v[140:143], v20 offset:4096
    v_mfma_f32_16x16x32_bf16 v[160:163], v[144:147], v[168:171], v[160:163]
    s_waitcnt lgkmcnt(4)
    v_mfma_f32_32x32x16_bf16 v[96:111], v[148:151], v[152:155], v[96:111]
    ds_read_b64_tr_b16 v[132:133], v14 offset:8192
    ds_read_b64_tr_b16 v[134:135], v14 offset:9216
    s_add_u32 m0, s68, 116736
    s_add_u32 s69, s47, 16384
    buffer_load_dwordx4 v9, s[40:43], s69 offen lds
    v_mfma_f32_32x32x16_bf16 v[112:127], v[148:151], v[156:159], v[112:127]
    s_add_u32 m0, s68, 101376
    s_add_u32 s69, s46, 43008
    buffer_load_dwordx4 v8, s[36:39], s69 offen lds
    s_waitcnt lgkmcnt(3)
    v_mfma_f32_32x32x16_bf16 v[64:79], v[128:131], v[136:139], v[64:79]
    ds_read_b64_tr_b16 v[144:145], v12 offset:12288
    ds_read_b64_tr_b16 v[146:147], v12 offset:13312
    s_waitcnt lgkmcnt(4)
    v_mfma_f32_32x32x16_bf16 v[80:95], v[128:131], v[140:143], v[80:95]
    ds_read_b128 v[152:155], v22 offset:0
    ds_read_b128 v[156:159], v22 offset:4096
    s_add_u32 m0, s68, 117760
    s_add_u32 s69, s47, 24576
    buffer_load_dwordx4 v10, s[40:43], s69 offen lds
    v_mfma_f32_16x16x32_bf16 v[160:163], v[128:131], v[168:171], v[160:163]
    s_waitcnt lgkmcnt(4)
    v_mfma_f32_32x32x16_bf16 v[96:111], v[132:135], v[136:139], v[96:111]
    ds_read_b64_tr_b16 v[148:149], v14 offset:12288
    ds_read_b64_tr_b16 v[150:151], v14 offset:13312
    v_mfma_f32_32x32x16_bf16 v[112:127], v[132:135], v[140:143], v[112:127]
    s_cmp_lg_u32 s99, 0
    s_cbranch_scc1 Ltq3
    s_and_b32 s59, s2, 7
    s_lshl_b32 s59, s59, 2
    s_add_u32 s59, s59, s3
    s_lshl_b32 s59, s59, 5
    s_lshr_b32 s60, s2, 3
    s_add_u32 s59, s59, s60
    s_lshl_b32 s59, s59, 7
    s_add_u32 s59, s59, 14745600
    s_lshl_b32 s53, s2, 7
    s_lshl_b32 s60, s3, 2
    s_add_u32 s53, s53, s60
    s_add_u32 s53, s53, 14893056
    v_mov_b32 v56, 0
    v_writelane_b32 v56, s59, 0
    v_writelane_b32 v56, s53, 1
    v_mov_b32 v57, s16
    s_mov_b64 exec, 3
    buffer_store_dword v57, v56, s[32:35], 0 offen sc1
    s_mov_b64 exec, -1
    s_mov_b32 s99, 1
Ltq3:
    s_waitcnt vmcnt(17)
    s_waitcnt lgkmcnt(0)
    s_barrier
    v_mfma_f32_32x32x16_bf16 v[64:79], v[144:147], v[152:155], v[64:79]
    ds_read_b64_tr_b16 v[128:129], v12 offset:32768
    ds_read_b64_tr_b16 v[130:131], v12 offset:33792
    s_waitcnt vmcnt(8)
    v_cmp_ne_u32 vcc, s16, v38
    s_nop 1
    s_cmp_eq_u64 vcc, 0
    s_cselect_b32 s101, 1, 0
    v_mfma_f32_32x32x16_bf16 v[80:95], v[144:147], v[156:159], v[80:95]
    ds_read_b128 v[136:139], v16 offset:32768
    ds_read_b128 v[140:143], v16 offset:36864
    s_cmp_eq_u32 s101, 1
    s_cbranch_scc1 Lwk4
    buffer_load_dword v38, v35, s[32:35], 0 offen sc1
    s_waitcnt vmcnt(0)
    s_mov_b32 s17, 0
Lpc5:
    v_cmp_ne_u32 vcc, s16, v38
    s_nop 1
    s_mov_b64 s[90:91], vcc
    s_cmp_eq_u64 s[90:91], 0
    s_cbranch_scc1 Lpd6
    s_add_u32 s17, s17, 1
    s_cmp_gt_u32 s17, 100000
    s_cbranch_scc1 Lpd6
    s_sleep 4
    buffer_load_dword v38, v35, s[32:35], 0 offen sc1
    s_waitcnt vmcnt(0)
    s_branch Lpc5
Lpd6:
Lwk4:
    v_lshlrev_b32 v240, 4, v1
    v_add_u32 v241, 114688, v240
    v_mfma_f32_16x16x32_bf16 v[160:163], v[144:147], v[168:171], v[160:163]
    v_mfma_f32_32x32x16_bf16 v[96:111], v[148:151], v[152:155], v[96:111]
    ds_read_b64_tr_b16 v[132:133], v14 offset:32768
    ds_read_b64_tr_b16 v[134:135], v14 offset:33792
    v_accvgpr_read_b32 v188, a224
    v_accvgpr_read_b32 v189, a225
    v_accvgpr_read_b32 v190, a226
    v_accvgpr_read_b32 v191, a227
    v_accvgpr_read_b32 v192, a228
    v_mfma_f32_32x32x16_bf16 v[112:127], v[148:151], v[156:159], v[112:127]
    v_accvgpr_read_b32 v193, a229
    v_accvgpr_read_b32 v194, a230
    v_accvgpr_read_b32 v195, a231
    v_accvgpr_read_b32 v196, a232
    v_accvgpr_read_b32 v197, a233
    v_accvgpr_read_b32 v198, a234
    s_waitcnt lgkmcnt(3)
    v_mfma_f32_32x32x16_bf16 v[64:79], v[128:131], v[136:139], v[64:79]
    ds_read_b64_tr_b16 v[144:145], v12 offset:36864
    ds_read_b64_tr_b16 v[146:147], v12 offset:37888
    v_accvgpr_read_b32 v199, a235
    s_add_u32 s87, s83, s84
    s_add_u32 s84, s84, 4096
    s_cmp_eq_u32 s84, 28672
    s_cselect_b32 s84, 0, s84
    buffer_load_dwordx4 a[0:3], v240, s[32:35], s87 offen offset:0 sc1
    s_waitcnt lgkmcnt(4)
    v_mfma_f32_32x32x16_bf16 v[80:95], v[128:131], v[140:143], v[80:95]
    ds_read_b128 v[152:155], v18 offset:32768
    ds_read_b128 v[156:159], v18 offset:36864
    v_cmp_eq_u32 vcc, 0, v0
    s_nop 1
    v_cndmask_b32_e64 v192, v192, 0, vcc
    v_cndmask_b32_e64 v193, v193, 0, vcc
    v_accvgpr_write_b32 a192, v188
    v_mfma_f32_16x16x32_bf16 v[160:163], v[128:131], v[168:171], v[160:163]
    s_waitcnt lgkmcnt(4)
    v_mfma_f32_32x32x16_bf16 v[96:111], v[132:135], v[136:139], v[96:111]
    ds_read_b64_tr_b16 v[148:149], v14 offset:36864
    ds_read_b64_tr_b16 v[150:151], v14 offset:37888
    v_accvgpr_write_b32 a193, v189
    v_accvgpr_write_b32 a194, v190
    v_accvgpr_write_b32 a195, v191
    v_alignbit_b32 v200, v188, v193, 16
    v_alignbit_b32 v201, v189, v188, 16
    v_alignbit_b32 v202, v190, v189, 16
    v_mfma_f32_32x32x16_bf16 v[112:127], v[132:135], v[140:143], v[112:127]
    v_alignbit_b32 v203, v191, v190, 16
    v_accvgpr_write_b32 a200, v193
    v_accvgpr_write_b32 a201, v188
    v_accvgpr_write_b32 a202, v189
    v_accvgpr_write_b32 a203, v190
    v_accvgpr_write_b32 a196, v200
    s_waitcnt lgkmcnt(3)
    v_mfma_f32_32x32x16_bf16 v[64:79], v[144:147], v[152:155], v[64:79]
    ds_read_b64_tr_b16 v[128:129], v12 offset:40960
    ds_read_b64_tr_b16 v[130:131], v12 offset:41984
    v_accvgpr_write_b32 a197, v201
    v_accvgpr_write_b32 a198, v202
    v_accvgpr_write_b32 a199, v203
    buffer_load_dwordx4 a[4:7], v241, s[32:35], s87 offen offset:0 sc1
    s_waitcnt lgkmcnt(4)
    v_mfma_f32_32x32x16_bf16 v[80:95], v[144:147], v[156:159], v[80:95]
    ds_read_b128 v[136:139], v20 offset:32768
    ds_read_b128 v[140:143], v20 offset:36864
    v_accvgpr_write_b32 a205, v200
    v_accvgpr_write_b32 a206, v201
    v_accvgpr_write_b32 a207, v202
    v_alignbit_b32 v200, v193, v192, 16
    v_accvgpr_write_b32 a204, v200
    v_mfma_f32_16x16x32_bf16 v[160:163], v[144:147], v[168:171], v[160:163]
    s_waitcnt lgkmcnt(4)
    v_mfma_f32_32x32x16_bf16 v[96:111], v[148:151], v[152:155], v[96:111]
    ds_read_b64_tr_b16 v[132:133], v14 offset:40960
    ds_read_b64_tr_b16 v[134:135], v14 offset:41984
    v_cndmask_b32_e64 v194, v194, 0, vcc
    v_cndmask_b32_e64 v195, v195, 0, vcc
    v_accvgpr_write_b32 a208, v196
    v_accvgpr_write_b32 a209, v197
    v_accvgpr_write_b32 a210, v198
    v_accvgpr_write_b32 a211, v199
    v_mfma_f32_32x32x16_bf16 v[112:127], v[148:151], v[156:159], v[112:127]
    buffer_load_dwordx4 a[8:11], v240, s[32:35], s87 offen offset:1024 sc1
    v_alignbit_b32 v200, v196, v195, 16
    v_alignbit_b32 v201, v197, v196, 16
    v_alignbit_b32 v202, v198, v197, 16
    s_waitcnt lgkmcnt(3)
    v_mfma_f32_32x32x16_bf16 v[64:79], v[128:131], v[136:139], v[64:79]
    ds_read_b64_tr_b16 v[144:145], v12 offset:45056
    ds_read_b64_tr_b16 v[146:147], v12 offset:46080
    v_alignbit_b32 v203, v199, v198, 16
    v_accvgpr_write_b32 a216, v195
    v_accvgpr_write_b32 a217, v196
    v_accvgpr_write_b32 a218, v197
    v_accvgpr_write_b32 a219, v198
    v_accvgpr_write_b32 a212, v200
    s_waitcnt lgkmcnt(4)
    v_mfma_f32_32x32x16_bf16 v[80:95], v[128:131], v[140:143], v[80:95]
    ds_read_b128 v[152:155], v22 offset:32768
    ds_read_b128 v[156:159], v22 offset:36864
    v_accvgpr_write_b32 a213, v201
    v_accvgpr_write_b32 a214, v202
    buffer_load_dwordx4 a[12:15], v241, s[32:35], s87 offen offset:1024 sc1
    v_mfma_f32_16x16x32_bf16 v[160:163], v[128:131], v[168:171], v[160:163]
    s_waitcnt lgkmcnt(4)
    v_mfma_f32_32x32x16_bf16 v[96:111], v[132:135], v[136:139], v[96:111]
    ds_read_b64_tr_b16 v[148:149], v14 offset:45056
    ds_read_b64_tr_b16 v[150:151], v14 offset:46080
    v_accvgpr_write_b32 a215, v203
    v_accvgpr_write_b32 a221, v200
    v_accvgpr_write_b32 a222, v201
    v_accvgpr_write_b32 a223, v202
    v_alignbit_b32 v200, v195, v194, 16
    v_accvgpr_write_b32 a220, v200
    v_mfma_f32_32x32x16_bf16 v[112:127], v[132:135], v[140:143], v[112:127]
    s_cmp_lg_u32 s99, 0
    s_cbranch_scc1 Ltq7
    s_and_b32 s59, s2, 7
    s_lshl_b32 s59, s59, 2
    s_add_u32 s59, s59, s3
    s_lshl_b32 s59, s59, 5
    s_lshr_b32 s60, s2, 3
    s_add_u32 s59, s59, s60
    s_lshl_b32 s59, s59, 7
    s_add_u32 s59, s59, 14745600
    s_lshl_b32 s53, s2, 7
    s_lshl_b32 s60, s3, 2
    s_add_u32 s53, s53, s60
    s_add_u32 s53, s53, 14893056
    v_mov_b32 v56, 0
    v_writelane_b32 v56, s59, 0
    v_writelane_b32 v56, s53, 1
    v_mov_b32 v57, s16
    s_mov_b64 exec, 3
    buffer_store_dword v57, v56, s[32:35], 0 offen sc1
    s_mov_b64 exec, -1
    s_mov_b32 s99, 1
Ltq7:
    s_waitcnt lgkmcnt(0)
    s_barrier
    v_mfma_f32_32x32x16_bf16 v[64:79], v[144:147], v[152:155], v[64:79]
    ds_read_b64_tr_b16 v[128:129], v13 offset:0
    ds_read_b64_tr_b16 v[130:131], v13 offset:1024
    v_mfma_f32_32x32x16_bf16 v[80:95], v[144:147], v[156:159], v[80:95]
    ds_read_b128 v[136:139], v17 offset:0
    ds_read_b128 v[140:143], v17 offset:4096
    v_and_b32 v32, 31, v1
    s_lshl_b32 s69, s71, 6
    s_add_u32 s69, s69, s63
    v_add_u32 v32, s69, v32
    v_and_b32 v33, 1, v32
    v_lshrrev_b32 v32, 1, v32
    v_lshlrev_b32 v32, 7, v32
    v_lshl_add_u32 v32, v33, 3, v32
    v_add_u32 v32, 15204352, v32
    v_add_u32 v33, 2048, v32
    buffer_load_dwordx2 v[28:29], v32, s[32:35], 0 offen sc1
    buffer_load_dwordx2 v[30:31], v33, s[32:35], 0 offen sc1
    v_mfma_f32_16x16x32_bf16 v[160:163], v[144:147], v[168:171], v[160:163]
    v_mfma_f32_32x32x16_bf16 v[96:111], v[148:151], v[152:155], v[96:111]
    ds_read_b64_tr_b16 v[132:133], v15 offset:0
    ds_read_b64_tr_b16 v[134:135], v15 offset:1024
    v_mfma_f32_32x32x16_bf16 v[112:127], v[148:151], v[156:159], v[112:127]
    s_waitcnt lgkmcnt(3)
    v_mfma_f32_32x32x16_bf16 v[64:79], v[128:131], v[136:139], v[64:79]
    ds_read_b64_tr_b16 v[144:145], v13 offset:4096
    ds_read_b64_tr_b16 v[146:147], v13 offset:5120
    buffer_load_dwordx4 a[16:19], v240, s[32:35], s87 offen offset:2048 sc1
    s_waitcnt lgkmcnt(4)
    v_mfma_f32_32x32x16_bf16 v[80:95], v[128:131], v[140:143], v[80:95]
    ds_read_b128 v[152:155], v19 offset:0
    ds_read_b128 v[156:159], v19 offset:4096
    v_mfma_f32_16x16x32_bf16 v[160:163], v[128:131], v[168:171], v[160:163]
    s_waitcnt lgkmcnt(4)
    v_mfma_f32_32x32x16_bf16 v[96:111], v[132:135], v[136:139], v[96:111]
    ds_read_b64_tr_b16 v[148:149], v15 offset:4096
    ds_read_b64_tr_b16 v[150:151], v15 offset:5120
    buffer_load_dwordx4 a[20:23], v241, s[32:35], s87 offen offset:2048 sc1
    v_mfma_f32_32x32x16_bf16 v[112:127], v[132:135], v[140:143], v[112:127]
    s_waitcnt lgkmcnt(3)
    v_mfma_f32_32x32x16_bf16 v[64:79], v[144:147], v[152:155], v[64:79]
    ds_read_b64_tr_b16 v[128:129], v13 offset:8192
    ds_read_b64_tr_b16 v[130:131], v13 offset:9216
    buffer_load_dwordx4 a[24:27], v240, s[32:35], s87 offen offset:3072 sc1
    s_waitcnt lgkmcnt(4)
    v_mfma_f32_32x32x16_bf16 v[80:95], v[144:147], v[156:159], v[80:95]
    ds_read_b128 v[136:139], v21 offset:0
    ds_read_b128 v[140:143], v21 offset:4096
    v_mfma_f32_16x16x32_bf16 v[160:163], v[144:147], v[168:171], v[160:163]
    s_waitcnt lgkmcnt(4)
    v_mfma_f32_32x32x16_bf16 v[96:111], v[148:151], v[152:155], v[96:111]
    ds_read_b64_tr_b16 v[132:133], v15 offset:8192
    ds_read_b64_tr_b16 v[134:135], v15 offset:9216
    buffer_load_dwordx4 a[28:31], v241, s[32:35], s87 offen offset:3072 sc1
    v_mfma_f32_32x32x16_bf16 v[112:127], v[148:151], v[156:159], v[112:127]
    s_waitcnt lgkmcnt(3)
    v_mfma_f32_32x32x16_bf16 v[64:79], v[128:131], v[136:139], v[64:79]
    ds_read_b64_tr_b16 v[144:145], v13 offset:12288
    ds_read_b64_tr_b16 v[146:147], v13 offset:13312
    s_waitcnt lgkmcnt(4)
    v_mfma_f32_32x32x16_bf16 v[80:95], v[128:131], v[140:143], v[80:95]
    ds_read_b128 v[152:155], v23 offset:0
    ds_read_b128 v[156:159], v23 offset:4096
    s_cmp_lg_u32 s99, 0
    s_cbranch_scc1 Ltq8
    s_and_b32 s59, s2, 7
    s_lshl_b32 s59, s59, 2
    s_add_u32 s59, s59, s3
    s_lshl_b32 s59, s59, 5
    s_lshr_b32 s60, s2, 3
    s_add_u32 s59, s59, s60
    s_lshl_b32 s59, s59, 7
    s_add_u32 s59, s59, 14745600
    s_lshl_b32 s53, s2, 7
    s_lshl_b32 s60, s3, 2
    s_add_u32 s53, s53, s60
    s_add_u32 s53, s53, 14893056
    v_mov_b32 v56, 0
    v_writelane_b32 v56, s59, 0
    v_writelane_b32 v56, s53, 1
    v_mov_b32 v57, s16
    s_mov_b64 exec, 3
    buffer_store_dword v57, v56, s[32:35], 0 offen sc1
    s_mov_b64 exec, -1
    s_mov_b32 s99, 1
Ltq8:
    v_mfma_f32_16x16x32_bf16 v[160:163], v[128:131], v[168:171], v[160:163]
    s_waitcnt lgkmcnt(4)
    v_mfma_f32_32x32x16_bf16 v[96:111], v[132:135], v[136:139], v[96:111]
    ds_read_b64_tr_b16 v[148:149], v15 offset:12288
    ds_read_b64_tr_b16 v[150:151], v15 offset:13312
    v_mfma_f32_32x32x16_bf16 v[112:127], v[132:135], v[140:143], v[112:127]
    s_waitcnt vmcnt(10)
    s_waitcnt lgkmcnt(0)
    s_barrier
    v_mfma_f32_32x32x16_bf16 v[64:79], v[144:147], v[152:155], v[64:79]
    ds_read_b64_tr_b16 v[128:129], v13 offset:32768
    ds_read_b64_tr_b16 v[130:131], v13 offset:33792
    s_cmp_lg_u32 s3, 0
    s_cbranch_scc1 Lw09
    s_lshr_b32 s73, s2, 5
    s_lshl_b32 s73, s73, 2
    s_bfe_u32 s74, s2, 0x20003
    s_add_u32 s73, s73, s74
    s_lshl_b32 s73, s73, 12
    s_add_u32 s73, s73, 14745600
    v_and_b32 v34, 31, v1
    v_lshl_add_u32 v34, v34, 7, s73
    buffer_load_dword v36, v34, s[32:35], 0 offen sc1
Lw09:
    v_mfma_f32_32x32x16_bf16 v[80:95], v[144:147], v[156:159], v[80:95]
    ds_read_b128 v[136:139], v17 offset:32768
    ds_read_b128 v[140:143], v17 offset:36864
    v_lshrrev_b32 v252, 5, v1
    v_lshlrev_b32 v252, 3, v252
    s_lshl_b32 s51, s70, 7
    s_lshl_b32 s52, s71, 6
    v_mfma_f32_16x16x32_bf16 v[160:163], v[144:147], v[168:171], v[160:163]
    v_mfma_f32_32x32x16_bf16 v[96:111], v[148:151], v[152:155], v[96:111]
    ds_read_b64_tr_b16 v[132:133], v15 offset:32768
    ds_read_b64_tr_b16 v[134:135], v15 offset:33792
    s_add_u32 s51, s51, s52
    s_add_u32 s51, s51, 156672
    v_add_u32 v252, s51, v252
    v_xor_b32 v253, 64, v252
    ds_read_b64 v[172:173], v252 offset:0
    v_mfma_f32_32x32x16_bf16 v[112:127], v[148:151], v[156:159], v[112:127]
    ds_read_b64 v[174:175], v252 offset:16
    s_waitcnt lgkmcnt(5)
    v_mfma_f32_32x32x16_bf16 v[64:79], v[128:131], v[136:139], v[64:79]
    ds_read_b64_tr_b16 v[144:145], v13 offset:36864
    ds_read_b64_tr_b16 v[146:147], v13 offset:37888
    s_add_u32 s87, s83, s84
    s_add_u32 s84, s84, 4096
    s_cmp_eq_u32 s84, 28672
    s_cselect_b32 s84, 0, s84
    buffer_load_dwordx4 a[32:35], v240, s[32:35], s87 offen offset:0 sc1
    ds_read_b64 v[176:177], v252 offset:32
    s_waitcnt lgkmcnt(7)
    v_mfma_f32_32x32x16_bf16 v[80:95], v[128:131], v[140:143], v[80:95]
    ds_read_b128 v[152:155], v19 offset:32768
    ds_read_b128 v[156:159], v19 offset:36864
    ds_read_b64 v[178:179], v252 offset:48
    ds_read_b64 v[180:181], v253 offset:0
    ds_read_b64 v[182:183], v253 offset:16
    v_mfma_f32_16x16x32_bf16 v[160:163], v[128:131], v[168:171], v[160:163]
    s_waitcnt lgkmcnt(10)
    v_mfma_f32_32x32x16_bf16 v[96:111], v[132:135], v[136:139], v[96:111]
    ds_read_b64_tr_b16 v[148:149], v15 offset:36864
    ds_read_b64_tr_b16 v[150:151], v15 offset:37888
    ds_read_b64 v[184:185], v253 offset:32
    ds_read_b64 v[186:187], v253 offset:48
    s_waitcnt lgkmcnt(6)
    v_lshlrev_b32 v192, 16, v172
    v_and_b32 v193, 0xffff0000, v172
    v_mfma_f32_32x32x16_bf16 v[112:127], v[132:135], v[140:143], v[112:127]
    v_lshlrev_b32 v194, 16, v173
    v_and_b32 v195, 0xffff0000, v173
    v_lshlrev_b32 v196, 16, v174
    v_and_b32 v197, 0xffff0000, v174
    v_lshlrev_b32 v198, 16, v175
    v_mfma_f32_32x32x16_bf16 v[64:79], v[144:147], v[152:155], v[64:79]
    ds_read_b64_tr_b16 v[128:129], v13 offset:40960
    ds_read_b64_tr_b16 v[130:131], v13 offset:41984
    v_and_b32 v199, 0xffff0000, v175
    buffer_load_dwordx4 a[36:39], v241, s[32:35], s87 offen offset:0 sc1
    v_lshlrev_b32 v200, 16, v176
    v_mfma_f32_32x32x16_bf16 v[80:95], v[144:147], v[156:159], v[80:95]
    ds_read_b128 v[136:139], v21 offset:32768
    ds_read_b128 v[140:143], v21 offset:36864
    v_and_b32 v201, 0xffff0000, v176
    v_lshlrev_b32 v202, 16, v177
    v_and_b32 v203, 0xffff0000, v177
    v_lshlrev_b32 v204, 16, v178
    v_and_b32 v205, 0xffff0000, v178
    v_mfma_f32_16x16x32_bf16 v[160:163], v[144:147], v[168:171], v[160:163]
    s_waitcnt lgkmcnt(6)
    v_mfma_f32_32x32x16_bf16 v[96:111], v[148:151], v[152:155], v[96:111]
    ds_read_b64_tr_b16 v[132:133], v15 offset:40960
    ds_read_b64_tr_b16 v[134:135], v15 offset:41984
    v_lshlrev_b32 v206, 16, v179
    v_and_b32 v207, 0xffff0000, v179
    s_waitcnt lgkmcnt(6)
    v_lshlrev_b32 v208, 16, v180
    buffer_load_dwordx4 a[40:43], v240, s[32:35], s87 offen offset:1024 sc1
    v_mfma_f32_32x32x16_bf16 v[112:127], v[148:151], v[156:159], v[112:127]
    v_and_b32 v209, 0xffff0000, v180
    v_lshlrev_b32 v210, 16, v181
    v_and_b32 v211, 0xffff0000, v181
    v_lshlrev_b32 v212, 16, v182
    s_waitcnt lgkmcnt(3)
    v_mfma_f32_32x32x16_bf16 v[64:79], v[128:131], v[136:139], v[64:79]
    ds_read_b64_tr_b16 v[144:145], v13 offset:45056
    ds_read_b64_tr_b16 v[146:147], v13 offset:46080
    v_and_b32 v213, 0xffff0000, v182
    v_lshlrev_b32 v214, 16, v183
    v_and_b32 v215, 0xffff0000, v183
    v_lshlrev_b32 v216, 16, v184
    v_and_b32 v217, 0xffff0000, v184
    s_waitcnt lgkmcnt(4)
    v_mfma_f32_32x32x16_bf16 v[80:95], v[128:131], v[140:143], v[80:95]
    ds_read_b128 v[152:155], v23 offset:32768
    ds_read_b128 v[156:159], v23 offset:36864
    v_lshlrev_b32 v218, 16, v185
    buffer_load_dwordx4 a[44:47], v241, s[32:35], s87 offen offset:1024 sc1
    v_and_b32 v219, 0xffff0000, v185
    v_mfma_f32_16x16x32_bf16 v[160:163], v[128:131], v[168:171], v[160:163]
    s_waitcnt lgkmcnt(4)
    v_mfma_f32_32x32x16_bf16 v[96:111], v[132:135], v[136:139], v[96:111]
    ds_read_b64_tr_b16 v[148:149], v15 offset:45056
    ds_read_b64_tr_b16 v[150:151], v15 offset:46080
    v_lshlrev_b32 v220, 16, v186
    v_and_b32 v221, 0xffff0000, v186
    v_lshlrev_b32 v222, 16, v187
    v_and_b32 v223, 0xffff0000, v187
    v_mfma_f32_32x32x16_bf16 v[112:127], v[132:135], v[140:143], v[112:127]
    s_cmp_lg_u32 s99, 0
    s_cbranch_scc1 Ltq10
    s_and_b32 s59, s2, 7
    s_lshl_b32 s59, s59, 2
    s_add_u32 s59, s59, s3
    s_lshl_b32 s59, s59, 5
    s_lshr_b32 s60, s2, 3
    s_add_u32 s59, s59, s60
    s_lshl_b32 s59, s59, 7
    s_add_u32 s59, s59, 14745600
    s_lshl_b32 s53, s2, 7
    s_lshl_b32 s60, s3, 2
    s_add_u32 s53, s53, s60
    s_add_u32 s53, s53, 14893056
    v_mov_b32 v56, 0
    v_writelane_b32 v56, s59, 0
    v_writelane_b32 v56, s53, 1
    v_mov_b32 v57, s16
    s_mov_b64 exec, 3
    buffer_store_dword v57, v56, s[32:35], 0 offen sc1
    s_mov_b64 exec, -1
    s_mov_b32 s99, 1
Ltq10:
    s_waitcnt lgkmcnt(3)
    v_mfma_f32_32x32x16_bf16 v[64:79], v[144:147], v[152:155], v[64:79]
    s_waitcnt lgkmcnt(2)
    v_mfma_f32_32x32x16_bf16 v[80:95], v[144:147], v[156:159], v[80:95]
    v_mfma_f32_16x16x32_bf16 v[160:163], v[144:147], v[168:171], v[160:163]
    s_waitcnt lgkmcnt(0)
    v_mfma_f32_32x32x16_bf16 v[96:111], v[148:151], v[152:155], v[96:111]
    v_mfma_f32_32x32x16_bf16 v[112:127], v[148:151], v[156:159], v[112:127]
    s_barrier
    v_and_b32 v24, 1, v1
    v_lshlrev_b32 v24, 6, v24
    v_lshrrev_b32 v25, 4, v1
    v_lshl_add_u32 v24, v25, 4, v24
    s_lshl_b32 s69, s70, 8
    s_lshl_b32 s72, s71, 7
    s_add_u32 s69, s69, s72
    v_add_u32 v24, s69, v24
    v_add_u32 v24, 131072, v24
    ds_write_b128 v24, v[160:163]
    s_cmp_lg_u32 s99, 0
    s_cbranch_scc1 Ltq11
    s_and_b32 s59, s2, 7
    s_lshl_b32 s59, s59, 2
    s_add_u32 s59, s59, s3
    s_lshl_b32 s59, s59, 5
    s_lshr_b32 s60, s2, 3
    s_add_u32 s59, s59, s60
    s_lshl_b32 s59, s59, 7
    s_add_u32 s59, s59, 14745600
    s_lshl_b32 s53, s2, 7
    s_lshl_b32 s60, s3, 2
    s_add_u32 s53, s53, s60
    s_add_u32 s53, s53, 14893056
    v_mov_b32 v56, 0
    v_writelane_b32 v56, s59, 0
    v_writelane_b32 v56, s53, 1
    v_mov_b32 v57, s16
    s_mov_b64 exec, 3
    buffer_store_dword v57, v56, s[32:35], 0 offen sc1
    s_mov_b64 exec, -1
    s_mov_b32 s99, 1
Ltq11:
    s_waitcnt vmcnt(8)
    s_mov_b32 s17, 0
Lpc12:
    v_cmp_ne_u32 vcc, s16, v29
    s_nop 1
    s_mov_b64 s[90:91], vcc
    v_cmp_ne_u32 vcc, s16, v31
    s_nop 1
    s_or_b64 s[90:91], s[90:91], vcc
    s_cmp_eq_u64 s[90:91], 0
    s_cbranch_scc1 Lpd13
    s_add_u32 s17, s17, 1
    s_cmp_gt_u32 s17, 100000
    s_cbranch_scc1 Lpd13
    s_sleep 4
    buffer_load_dwordx2 v[28:29], v32, s[32:35], 0 offen sc1
    buffer_load_dwordx2 v[30:31], v33, s[32:35], 0 offen sc1
    s_waitcnt vmcnt(0)
    s_branch Lpc12
Lpd13:
    s_cmp_lg_u32 s3, 0
    s_cbranch_scc1 Lw014
    s_waitcnt vmcnt(4)
    s_mov_b32 s96, 0
    v_cmp_ne_u32 vcc, s16, v36
    s_nop 1
    s_cmp_eq_u64 vcc, 0
    s_cbranch_scc0 Lkt15
    s_mov_b32 s96, 1
    s_lshl_b32 s73, s2, 13
    s_add_u32 s73, s73, 0
    v_lshlrev_b32 v37, 4, v1
    buffer_load_dwordx4 a[224:227], v37, s[32:35], s73 offen offset:0 sc1
    buffer_load_dwordx4 a[228:231], v37, s[32:35], s73 offen offset:1024 sc1
    buffer_load_dwordx4 a[232:235], v37, s[32:35], s73 offen offset:2048 sc1
    buffer_load_dwordx4 a[236:239], v37, s[32:35], s73 offen offset:3072 sc1
    s_add_u32 s73, s73, 4096
    buffer_load_dwordx4 a[240:243], v37, s[32:35], s73 offen offset:0 sc1
    buffer_load_dwordx4 a[244:247], v37, s[32:35], s73 offen offset:1024 sc1
    buffer_load_dwordx4 a[248:251], v37, s[32:35], s73 offen offset:2048 sc1
    buffer_load_dwordx4 a[252:255], v37, s[32:35], s73 offen offset:3072 sc1
Lkt15:
Lw014:
    v_and_b32 v29, 0xffff0000, v28
    v_lshlrev_b32 v28, 16, v28
    v_rcp_f32 v29, v29
    v_xor_b32 v28, 0x80000000, v28
    v_and_b32 v31, 0xffff0000, v30
    v_lshlrev_b32 v30, 16, v30
    v_rcp_f32 v31, v31
    v_xor_b32 v30, 0x80000000, v30
    s_waitcnt lgkmcnt(0)
    s_barrier
    v_lshrrev_b32 v24, 5, v1
    v_lshlrev_b32 v24, 4, v24
    s_lshl_b32 s69, s70, 8
    s_lshl_b32 s72, s71, 7
    s_add_u32 s69, s69, s72
    s_add_u32 s69, s69, 131072
    v_add_u32 v24, s69, v24
    v_xor_b32 v25, 128, v24
    ds_read_b128 v[128:131], v24 offset:0
    ds_read_b128 v[132:135], v24 offset:32
    ds_read_b128 v[136:139], v24 offset:64
    ds_read_b128 v[140:143], v24 offset:96
    ds_read_b128 v[144:147], v25 offset:0
    ds_read_b128 v[148:151], v25 offset:32
    ds_read_b128 v[152:155], v25 offset:64
    ds_read_b128 v[156:159], v25 offset:96
    s_lshl_b32 s98, s71, 6
    s_add_u32 s98, s98, s63
    s_lshr_b32 s98, s98, 5
    s_mul_i32 s98, s98, 112
    s_lshl_b32 s97, s70, 6
    s_add_u32 s97, s97, s64
    s_lshr_b32 s97, s97, 4
    s_add_u32 s98, s98, s97
    s_lshl_b32 s98, s98, 10
    s_add_u32 s98, s98, 6291456
    s_lshl_b32 s97, s71, 11
    v_lshlrev_b32 v232, 4, v1
    s_waitcnt lgkmcnt(4)
    v_pk_fma_f32 v[64:65], v[128:129], v[28:29], v[64:65] op_sel_hi:[1,0,1]
    v_pk_fma_f32 v[66:67], v[130:131], v[28:29], v[66:67] op_sel_hi:[1,0,1]
    v_pk_fma_f32 v[68:69], v[132:133], v[28:29], v[68:69] op_sel_hi:[1,0,1]
    v_pk_fma_f32 v[70:71], v[134:135], v[28:29], v[70:71] op_sel_hi:[1,0,1]
    v_pk_fma_f32 v[64:65], v[64:65], v[28:29], v[192:193] op_sel:[0,1,0] op_sel_hi:[1,1,1]
    v_pk_fma_f32 v[66:67], v[66:67], v[28:29], v[194:195] op_sel:[0,1,0] op_sel_hi:[1,1,1]
    v_pk_fma_f32 v[68:69], v[68:69], v[28:29], v[196:197] op_sel:[0,1,0] op_sel_hi:[1,1,1]
    v_pk_fma_f32 v[70:71], v[70:71], v[28:29], v[198:199] op_sel:[0,1,0] op_sel_hi:[1,1,1]
    v_max_f32 v64, 0, v64
    v_max_f32 v65, 0, v65
    v_max_f32 v66, 0, v66
    v_max_f32 v67, 0, v67
    v_max_f32 v68, 0, v68
    v_max_f32 v69, 0, v69
    v_max_f32 v70, 0, v70
    v_max_f32 v71, 0, v71
    v_pk_mul_f32 v[64:65], v[64:65], v[64:65]
    v_pk_mul_f32 v[66:67], v[66:67], v[66:67]
    v_pk_mul_f32 v[68:69], v[68:69], v[68:69]
    v_pk_mul_f32 v[70:71], v[70:71], v[70:71]
    v_cvt_pk_bf16_f32 v40, v64, v65
    v_cvt_pk_bf16_f32 v41, v66, v67
    v_cvt_pk_bf16_f32 v42, v68, v69
    v_cvt_pk_bf16_f32 v43, v70, v71
    s_xor_b32 s46, s97, 0
    s_add_u32 s46, s46, s98
    s_add_u32 s46, s46, 0
    buffer_store_dwordx4 v[40:43], v232, s[32:35], s46 offen sc1
    v_pk_fma_f32 v[72:73], v[136:137], v[28:29], v[72:73] op_sel_hi:[1,0,1]
    v_pk_fma_f32 v[74:75], v[138:139], v[28:29], v[74:75] op_sel_hi:[1,0,1]
    v_pk_fma_f32 v[76:77], v[140:141], v[28:29], v[76:77] op_sel_hi:[1,0,1]
    v_pk_fma_f32 v[78:79], v[142:143], v[28:29], v[78:79] op_sel_hi:[1,0,1]
    v_pk_fma_f32 v[72:73], v[72:73], v[28:29], v[200:201] op_sel:[0,1,0] op_sel_hi:[1,1,1]
    v_pk_fma_f32 v[74:75], v[74:75], v[28:29], v[202:203] op_sel:[0,1,0] op_sel_hi:[1,1,1]
    v_pk_fma_f32 v[76:77], v[76:77], v[28:29], v[204:205] op_sel:[0,1,0] op_sel_hi:[1,1,1]
    v_pk_fma_f32 v[78:79], v[78:79], v[28:29], v[206:207] op_sel:[0,1,0] op_sel_hi:[1,1,1]
    v_max_f32 v72, 0, v72
    v_max_f32 v73, 0, v73
    v_max_f32 v74, 0, v74
    v_max_f32 v75, 0, v75
    v_max_f32 v76, 0, v76
    v_max_f32 v77, 0, v77
    v_max_f32 v78, 0, v78
    v_max_f32 v79, 0, v79
    v_pk_mul_f32 v[72:73], v[72:73], v[72:73]
    v_pk_mul_f32 v[74:75], v[74:75], v[74:75]
    v_pk_mul_f32 v[76:77], v[76:77], v[76:77]
    v_pk_mul_f32 v[78:79], v[78:79], v[78:79]
    v_cvt_pk_bf16_f32 v44, v72, v73
    v_cvt_pk_bf16_f32 v45, v74, v75
    v_cvt_pk_bf16_f32 v46, v76, v77
    v_cvt_pk_bf16_f32 v47, v78, v79
    s_xor_b32 s46, s97, 0
    s_add_u32 s46, s46, s98
    s_add_u32 s46, s46, 1024
    buffer_store_dwordx4 v[44:47], v232, s[32:35], s46 offen sc1
    v_pk_fma_f32 v[80:81], v[128:129], v[30:31], v[80:81] op_sel_hi:[1,0,1]
    v_pk_fma_f32 v[82:83], v[130:131], v[30:31], v[82:83] op_sel_hi:[1,0,1]
    v_pk_fma_f32 v[84:85], v[132:133], v[30:31], v[84:85] op_sel_hi:[1,0,1]
    v_pk_fma_f32 v[86:87], v[134:135], v[30:31], v[86:87] op_sel_hi:[1,0,1]
    v_pk_fma_f32 v[80:81], v[80:81], v[30:31], v[192:193] op_sel:[0,1,0] op_sel_hi:[1,1,1]
    v_pk_fma_f32 v[82:83], v[82:83], v[30:31], v[194:195] op_sel:[0,1,0] op_sel_hi:[1,1,1]
    v_pk_fma_f32 v[84:85], v[84:85], v[30:31], v[196:197] op_sel:[0,1,0] op_sel_hi:[1,1,1]
    v_pk_fma_f32 v[86:87], v[86:87], v[30:31], v[198:199] op_sel:[0,1,0] op_sel_hi:[1,1,1]
    v_max_f32 v80, 0, v80
    v_max_f32 v81, 0, v81
    v_max_f32 v82, 0, v82
    v_max_f32 v83, 0, v83
    v_max_f32 v84, 0, v84
    v_max_f32 v85, 0, v85
    v_max_f32 v86, 0, v86
    v_max_f32 v87, 0, v87
    v_pk_mul_f32 v[80:81], v[80:81], v[80:81]
    v_pk_mul_f32 v[82:83], v[82:83], v[82:83]
    v_pk_mul_f32 v[84:85], v[84:85], v[84:85]
    v_pk_mul_f32 v[86:87], v[86:87], v[86:87]
    v_cvt_pk_bf16_f32 v48, v80, v81
    v_cvt_pk_bf16_f32 v49, v82, v83
    v_cvt_pk_bf16_f32 v50, v84, v85
    v_cvt_pk_bf16_f32 v51, v86, v87
    s_xor_b32 s46, s97, 0
    s_add_u32 s46, s46, s98
    s_add_u32 s46, s46, 114688
    buffer_store_dwordx4 v[48:51], v232, s[32:35], s46 offen sc1
    v_pk_fma_f32 v[88:89], v[136:137], v[30:31], v[88:89] op_sel_hi:[1,0,1]
    v_pk_fma_f32 v[90:91], v[138:139], v[30:31], v[90:91] op_sel_hi:[1,0,1]
    v_pk_fma_f32 v[92:93], v[140:141], v[30:31], v[92:93] op_sel_hi:[1,0,1]
    v_pk_fma_f32 v[94:95], v[142:143], v[30:31], v[94:95] op_sel_hi:[1,0,1]
    v_pk_fma_f32 v[88:89], v[88:89], v[30:31], v[200:201] op_sel:[0,1,0] op_sel_hi:[1,1,1]
    v_pk_fma_f32 v[90:91], v[90:91], v[30:31], v[202:203] op_sel:[0,1,0] op_sel_hi:[1,1,1]
    v_pk_fma_f32 v[92:93], v[92:93], v[30:31], v[204:205] op_sel:[0,1,0] op_sel_hi:[1,1,1]
    v_pk_fma_f32 v[94:95], v[94:95], v[30:31], v[206:207] op_sel:[0,1,0] op_sel_hi:[1,1,1]
    v_max_f32 v88, 0, v88
    v_max_f32 v89, 0, v89
    v_max_f32 v90, 0, v90
    v_max_f32 v91, 0, v91
    v_max_f32 v92, 0, v92
    v_max_f32 v93, 0, v93
    v_max_f32 v94, 0, v94
    v_max_f32 v95, 0, v95
    v_pk_mul_f32 v[88:89], v[88:89], v[88:89]
    v_pk_mul_f32 v[90:91], v[90:91], v[90:91]
    v_pk_mul_f32 v[92:93], v[92:93], v[92:93]
    v_pk_mul_f32 v[94:95], v[94:95], v[94:95]
    v_cvt_pk_bf16_f32 v52, v88, v89
    v_cvt_pk_bf16_f32 v53, v90, v91
    v_cvt_pk_bf16_f32 v54, v92, v93
    v_cvt_pk_bf16_f32 v55, v94, v95
    s_xor_b32 s46, s97, 0
    s_add_u32 s46, s46, s98
    s_add_u32 s46, s46, 115712
    buffer_store_dwordx4 v[52:55], v232, s[32:35], s46 offen sc1
    s_waitcnt lgkmcnt(0)
    v_pk_fma_f32 v[96:97], v[144:145], v[28:29], v[96:97] op_sel_hi:[1,0,1]
    v_pk_fma_f32 v[98:99], v[146:147], v[28:29], v[98:99] op_sel_hi:[1,0,1]
    v_pk_fma_f32 v[100:101], v[148:149], v[28:29], v[100:101] op_sel_hi:[1,0,1]
    v_pk_fma_f32 v[102:103], v[150:151], v[28:29], v[102:103] op_sel_hi:[1,0,1]
    v_pk_fma_f32 v[96:97], v[96:97], v[28:29], v[208:209] op_sel:[0,1,0] op_sel_hi:[1,1,1]
    v_pk_fma_f32 v[98:99], v[98:99], v[28:29], v[210:211] op_sel:[0,1,0] op_sel_hi:[1,1,1]
    v_pk_fma_f32 v[100:101], v[100:101], v[28:29], v[212:213] op_sel:[0,1,0] op_sel_hi:[1,1,1]
    v_pk_fma_f32 v[102:103], v[102:103], v[28:29], v[214:215] op_sel:[0,1,0] op_sel_hi:[1,1,1]
    v_max_f32 v96, 0, v96
    v_max_f32 v97, 0, v97
    v_max_f32 v98, 0, v98
    v_max_f32 v99, 0, v99
    v_max_f32 v100, 0, v100
    v_max_f32 v101, 0, v101
    v_max_f32 v102, 0, v102
    v_max_f32 v103, 0, v103
    v_pk_mul_f32 v[96:97], v[96:97], v[96:97]
    v_pk_mul_f32 v[98:99], v[98:99], v[98:99]
    v_pk_mul_f32 v[100:101], v[100:101], v[100:101]
    v_pk_mul_f32 v[102:103], v[102:103], v[102:103]
    v_cvt_pk_bf16_f32 v56, v96, v97
    v_cvt_pk_bf16_f32 v57, v98, v99
    v_cvt_pk_bf16_f32 v58, v100, v101
    v_cvt_pk_bf16_f32 v59, v102, v103
    s_xor_b32 s46, s97, 2048
    s_add_u32 s46, s46, s98
    s_add_u32 s46, s46, 0
    buffer_store_dwordx4 v[56:59], v232, s[32:35], s46 offen sc1
    v_pk_fma_f32 v[104:105], v[152:153], v[28:29], v[104:105] op_sel_hi:[1,0,1]
    v_pk_fma_f32 v[106:107], v[154:155], v[28:29], v[106:107] op_sel_hi:[1,0,1]
    v_pk_fma_f32 v[108:109], v[156:157], v[28:29], v[108:109] op_sel_hi:[1,0,1]
    v_pk_fma_f32 v[110:111], v[158:159], v[28:29], v[110:111] op_sel_hi:[1,0,1]
    v_pk_fma_f32 v[104:105], v[104:105], v[28:29], v[216:217] op_sel:[0,1,0] op_sel_hi:[1,1,1]
    v_pk_fma_f32 v[106:107], v[106:107], v[28:29], v[218:219] op_sel:[0,1,0] op_sel_hi:[1,1,1]
    v_pk_fma_f32 v[108:109], v[108:109], v[28:29], v[220:221] op_sel:[0,1,0] op_sel_hi:[1,1,1]
    v_pk_fma_f32 v[110:111], v[110:111], v[28:29], v[222:223] op_sel:[0,1,0] op_sel_hi:[1,1,1]
    v_max_f32 v104, 0, v104
    v_max_f32 v105, 0, v105
    v_max_f32 v106, 0, v106
    v_max_f32 v107, 0, v107
    v_max_f32 v108, 0, v108
    v_max_f32 v109, 0, v109
    v_max_f32 v110, 0, v110
    v_max_f32 v111, 0, v111
    v_pk_mul_f32 v[104:105], v[104:105], v[104:105]
    v_pk_mul_f32 v[106:107], v[106:107], v[106:107]
    v_pk_mul_f32 v[108:109], v[108:109], v[108:109]
    v_pk_mul_f32 v[110:111], v[110:111], v[110:111]
    v_cvt_pk_bf16_f32 v60, v104, v105
    v_cvt_pk_bf16_f32 v61, v106, v107
    v_cvt_pk_bf16_f32 v62, v108, v109
    v_cvt_pk_bf16_f32 v63, v110, v111
    s_xor_b32 s46, s97, 2048
    s_add_u32 s46, s46, s98
    s_add_u32 s46, s46, 1024
    buffer_store_dwordx4 v[60:63], v232, s[32:35], s46 offen sc1
    v_pk_fma_f32 v[112:113], v[144:145], v[30:31], v[112:113] op_sel_hi:[1,0,1]
    v_pk_fma_f32 v[114:115], v[146:147], v[30:31], v[114:115] op_sel_hi:[1,0,1]
    v_pk_fma_f32 v[116:117], v[148:149], v[30:31], v[116:117] op_sel_hi:[1,0,1]
    v_pk_fma_f32 v[118:119], v[150:151], v[30:31], v[118:119] op_sel_hi:[1,0,1]
    v_pk_fma_f32 v[112:113], v[112:113], v[30:31], v[208:209] op_sel:[0,1,0] op_sel_hi:[1,1,1]
    v_pk_fma_f32 v[114:115], v[114:115], v[30:31], v[210:211] op_sel:[0,1,0] op_sel_hi:[1,1,1]
    v_pk_fma_f32 v[116:117], v[116:117], v[30:31], v[212:213] op_sel:[0,1,0] op_sel_hi:[1,1,1]
    v_pk_fma_f32 v[118:119], v[118:119], v[30:31], v[214:215] op_sel:[0,1,0] op_sel_hi:[1,1,1]
    v_max_f32 v112, 0, v112
    v_max_f32 v113, 0, v113
    v_max_f32 v114, 0, v114
    v_max_f32 v115, 0, v115
    v_max_f32 v116, 0, v116
    v_max_f32 v117, 0, v117
    v_max_f32 v118, 0, v118
    v_max_f32 v119, 0, v119
    v_pk_mul_f32 v[112:113], v[112:113], v[112:113]
    v_pk_mul_f32 v[114:115], v[114:115], v[114:115]
    v_pk_mul_f32 v[116:117], v[116:117], v[116:117]
    v_pk_mul_f32 v[118:119], v[118:119], v[118:119]
    v_cvt_pk_bf16_f32 v224, v112, v113
    v_cvt_pk_bf16_f32 v225, v114, v115
    v_cvt_pk_bf16_f32 v226, v116, v117
    v_cvt_pk_bf16_f32 v227, v118, v119
    s_xor_b32 s46, s97, 2048
    s_add_u32 s46, s46, s98
    s_add_u32 s46, s46, 114688
    buffer_store_dwordx4 v[224:227], v232, s[32:35], s46 offen sc1
    v_pk_fma_f32 v[120:121], v[152:153], v[30:31], v[120:121] op_sel_hi:[1,0,1]
    v_pk_fma_f32 v[122:123], v[154:155], v[30:31], v[122:123] op_sel_hi:[1,0,1]
    v_pk_fma_f32 v[124:125], v[156:157], v[30:31], v[124:125] op_sel_hi:[1,0,1]
    v_pk_fma_f32 v[126:127], v[158:159], v[30:31], v[126:127] op_sel_hi:[1,0,1]
    v_pk_fma_f32 v[120:121], v[120:121], v[30:31], v[216:217] op_sel:[0,1,0] op_sel_hi:[1,1,1]
    v_pk_fma_f32 v[122:123], v[122:123], v[30:31], v[218:219] op_sel:[0,1,0] op_sel_hi:[1,1,1]
    v_pk_fma_f32 v[124:125], v[124:125], v[30:31], v[220:221] op_sel:[0,1,0] op_sel_hi:[1,1,1]
    v_pk_fma_f32 v[126:127], v[126:127], v[30:31], v[222:223] op_sel:[0,1,0] op_sel_hi:[1,1,1]
    v_max_f32 v120, 0, v120
    v_max_f32 v121, 0, v121
    v_max_f32 v122, 0, v122
    v_max_f32 v123, 0, v123
    v_max_f32 v124, 0, v124
    v_max_f32 v125, 0, v125
    v_max_f32 v126, 0, v126
    v_max_f32 v127, 0, v127
    v_pk_mul_f32 v[120:121], v[120:121], v[120:121]
    v_pk_mul_f32 v[122:123], v[122:123], v[122:123]
    v_pk_mul_f32 v[124:125], v[124:125], v[124:125]
    v_pk_mul_f32 v[126:127], v[126:127], v[126:127]
    v_cvt_pk_bf16_f32 v228, v120, v121
    v_cvt_pk_bf16_f32 v229, v122, v123
    v_cvt_pk_bf16_f32 v230, v124, v125
    v_cvt_pk_bf16_f32 v231, v126, v127
    s_xor_b32 s46, s97, 2048
    s_add_u32 s46, s46, s98
    s_add_u32 s46, s46, 115712
    buffer_store_dwordx4 v[228:231], v232, s[32:35], s46 offen sc1
    s_cmp_lg_u32 s99, 0
    s_cbranch_scc1 Ltq16
    s_and_b32 s59, s2, 7
    s_lshl_b32 s59, s59, 2
    s_add_u32 s59, s59, s3
    s_lshl_b32 s59, s59, 5
    s_lshr_b32 s60, s2, 3
    s_add_u32 s59, s59, s60
    s_lshl_b32 s59, s59, 7
    s_add_u32 s59, s59, 14745600
    s_lshl_b32 s53, s2, 7
    s_lshl_b32 s60, s3, 2
    s_add_u32 s53, s53, s60
    s_add_u32 s53, s53, 14893056
    v_mov_b32 v56, 0
    v_writelane_b32 v56, s59, 0
    v_writelane_b32 v56, s53, 1
    v_mov_b32 v57, s16
    s_mov_b64 exec, 3
    buffer_store_dword v57, v56, s[32:35], 0 offen sc1
    s_mov_b64 exec, -1
    s_mov_b32 s99, 1
Ltq16:
    v_lshlrev_b32 v8, 4, v0
    v_add_u32 v9, 32800, v8
    ds_write_b128 v9, a[192:195] offset:0
    ds_write_b128 v9, a[196:199] offset:4160
    ds_write_b128 v9, a[200:203] offset:8320
    ds_write_b128 v9, a[204:207] offset:12480
    ds_write_b128 v9, a[208:211] offset:16640
    ds_write_b128 v9, a[212:215] offset:20800
    ds_write_b128 v9, a[216:219] offset:24960
    ds_write_b128 v9, a[220:223] offset:29120
    v_mov_b64 v[12:13], 0
    v_mov_b64 v[14:15], 0
    v_lshrrev_b32 v10, 1, v0
    v_and_b32 v11, 3, v10
    v_mul_u32_u24 v11, 4160, v11
    v_bfe_u32 v10, v0, 3, 1
    v_mul_u32_u24 v10, 16640, v10
    v_add_u32 v11, v11, v10
    v_and_b32 v10, 1, v0
    v_lshl_add_u32 v11, v10, 4, v11
    v_add_u32 v11, 32768, v11
    v_subrev_u32 v10, 16, v0
    v_and_b32 v16, 31, v10
    v_lshlrev_b32 v16, 4, v16
    v_bfe_u32 v10, v10, 5, 1
    v_mul_u32_u24 v10, 4608, v10
    v_add_u32 v16, v16, v10
    v_cmp_gt_u32 vcc, 16, v0
    s_nop 1
    v_cndmask_b32 v11, v16, v11, vcc
    v_cmp_gt_u32 vcc, 80, v0
    s_nop 1
    s_and_saveexec_b64 s[76:77], vcc
    s_cbranch_execz Lcz17
    ds_write_b128 v11, v[12:15]
Lcz17:
    s_mov_b64 exec, s[76:77]
    s_cmp_lg_u32 s3, 0
    s_cbranch_scc1 Lw018
    s_cmp_eq_u32 s96, 1
    s_cbranch_scc1 Lkv19
    buffer_load_dword v36, v34, s[32:35], 0 offen sc1
    s_waitcnt vmcnt(0)
    s_mov_b32 s17, 0
Lpc20:
    v_cmp_ne_u32 vcc, s16, v36
    s_nop 1
    s_mov_b64 s[90:91], vcc
    s_cmp_eq_u64 s[90:91], 0
    s_cbranch_scc1 Lpd21
    s_add_u32 s17, s17, 1
    s_cmp_gt_u32 s17, 100000
    s_cbranch_scc1 Lpd21
    s_sleep 4
    buffer_load_dword v36, v34, s[32:35], 0 offen sc1
    s_waitcnt vmcnt(0)
    s_branch Lpc20
Lpd21:
    s_lshl_b32 s73, s2, 13
    s_add_u32 s73, s73, 0
    v_lshlrev_b32 v37, 4, v1
    buffer_load_dwordx4 a[224:227], v37, s[32:35], s73 offen offset:0 sc1
    buffer_load_dwordx4 a[228:231], v37, s[32:35], s73 offen offset:1024 sc1
    buffer_load_dwordx4 a[232:235], v37, s[32:35], s73 offen offset:2048 sc1
    buffer_load_dwordx4 a[236:239], v37, s[32:35], s73 offen offset:3072 sc1
    s_add_u32 s73, s73, 4096
    buffer_load_dwordx4 a[240:243], v37, s[32:35], s73 offen offset:0 sc1
    buffer_load_dwordx4 a[244:247], v37, s[32:35], s73 offen offset:1024 sc1
    buffer_load_dwordx4 a[248:251], v37, s[32:35], s73 offen offset:2048 sc1
    buffer_load_dwordx4 a[252:255], v37, s[32:35], s73 offen offset:3072 sc1
    s_waitcnt vmcnt(0)
Lkv19:
Lw018:
    s_mov_b32 s100, 0
    s_cmp_lg_u32 s3, 0
    s_cbranch_scc1 Lw022
    v_lshlrev_b32 v8, 4, v1
    s_waitcnt vmcnt(8)
    ds_write_b128 v8, a[224:227] offset:512
    ds_write_b128 v8, a[228:231] offset:1536
    ds_write_b128 v8, a[232:235] offset:2560
    ds_write_b128 v8, a[236:239] offset:3584
    ds_write_b128 v8, a[240:243] offset:5120
    ds_write_b128 v8, a[244:247] offset:6144
    ds_write_b128 v8, a[248:251] offset:7168
    ds_write_b128 v8, a[252:255] offset:8192
Lw022:
    s_branch Ljoin
Lidle:
    s_mov_b32 s44, s22
    s_mov_b32 s45, s23
    s_mov_b32 s46, 0x1c0000
    s_mov_b32 s47, 0x20000
    s_sub_u32 s54, s62, 28
    s_mul_i32 s55, s54, 448
    s_mul_i32 s56, s3, 112
    s_add_u32 s55, s55, s56
    s_lshl_b32 s55, s55, 10
    s_lshl_b32 s56, s61, 7
    s_add_u32 s55, s55, s56
    v_lshrrev_b32 v8, 3, v1
    v_lshlrev_b32 v8, 10, v8
    v_and_b32 v9, 7, v1
    v_lshl_add_u32 v8, v9, 4, v8
    s_mul_i32 s56, s3, 14336
    s_add_u32 m0, s56, 0
    s_add_u32 s57, s55, 0
    buffer_load_dwordx4 v8, s[44:47], s57 offen lds
    s_add_u32 m0, s56, 1024
    s_add_u32 s57, s55, 8192
    buffer_load_dwordx4 v8, s[44:47], s57 offen lds
    s_add_u32 m0, s56, 2048
    s_add_u32 s57, s55, 16384
    buffer_load_dwordx4 v8, s[44:47], s57 offen lds
    s_add_u32 m0, s56, 3072
    s_add_u32 s57, s55, 24576
    buffer_load_dwordx4 v8, s[44:47], s57 offen lds
    s_add_u32 m0, s56, 4096
    s_add_u32 s57, s55, 32768
    buffer_load_dwordx4 v8, s[44:47], s57 offen lds
    s_add_u32 m0, s56, 5120
    s_add_u32 s57, s55, 40960
    buffer_load_dwordx4 v8, s[44:47], s57 offen lds
    s_add_u32 m0, s56, 6144
    s_add_u32 s57, s55, 49152
    buffer_load_dwordx4 v8, s[44:47], s57 offen lds
    s_add_u32 m0, s56, 7168
    s_add_u32 s57, s55, 57344
    buffer_load_dwordx4 v8, s[44:47], s57 offen lds
    s_add_u32 m0, s56, 8192
    s_add_u32 s57, s55, 65536
    buffer_load_dwordx4 v8, s[44:47], s57 offen lds
    s_add_u32 m0, s56, 9216
    s_add_u32 s57, s55, 73728
    buffer_load_dwordx4 v8, s[44:47], s57 offen lds
    s_add_u32 m0, s56, 10240
    s_add_u32 s57, s55, 81920
    buffer_load_dwordx4 v8, s[44:47], s57 offen lds
    s_add_u32 m0, s56, 11264
    s_add_u32 s57, s55, 90112
    buffer_load_dwordx4 v8, s[44:47], s57 offen lds
    s_add_u32 m0, s56, 12288
    s_add_u32 s57, s55, 98304
    buffer_load_dwordx4 v8, s[44:47], s57 offen lds
    s_add_u32 m0, s56, 13312
    s_add_u32 s57, s55, 106496
    buffer_load_dwordx4 v8, s[44:47], s57 offen lds
    s_lshr_b32 s48, s2, 3
    s_lshl_b32 s48, s48, 6
    s_and_b32 s49, s2, 7
    s_lshl_b32 s49, s49, 7
    v_lshrrev_b32 v42, 3, v1
    v_lshlrev_b32 v42, 10, v42
    v_and_b32 v43, 7, v1
    v_lshl_add_u32 v42, v43, 4, v42
    s_lshl_b32 s50, s48, 10
    s_add_u32 s50, s50, s49
    s_sub_u32 s51, s50, 8192
    v_add_u32 v43, s51, v42
    s_lshl_b32 s51, s3, 14
    s_add_u32 s51, s51, s50
    s_lshl_b32 s52, s3, 11
    v_and_b32 v44, 15, v1
    s_lshl_b32 s59, s3, 4
    s_lshr_b32 s60, s49, 1
    s_add_u32 s59, s59, s60
    v_add_u32 v58, s59, v44
    v_lshlrev_b32 v44, 3, v58
    s_lshl_b32 s73, s2, 13
    v_lshl_add_u32 v244, v0, 4, s73
    v_subrev_u32 v245, 8, v244
    v_max_i32 v245, 0, v245
    v_add_u32 v246, 4096, v244
    v_add_u32 v247, 4096, v245
    s_lshl_b32 s74, s2, 2
    s_load_dword s75, s[14:15], s74
    s_mov_b32 s96, s6
    s_mov_b32 s97, s7
    s_mov_b32 s98, 0x200000
    s_mov_b32 s99, 0x20000
    s_cmp_lg_u32 s3, 0
    s_cbranch_scc1 Lpre_hist776_1
    s_mov_b32 m0, 131072
    s_nop 0
    buffer_load_dwordx4 v43, s[96:99], 0 offen lds
Lpre_hist776_1:
    s_add_u32 s53, s51, 0
    s_add_u32 m0, s52, 132096
    s_nop 0
    buffer_load_dwordx4 v42, s[96:99], s53 offen lds
    s_add_u32 s53, s51, 8192
    s_add_u32 m0, s52, 133120
    s_nop 0
    buffer_load_dwordx4 v42, s[96:99], s53 offen lds
    s_mov_b32 s96, s8
    s_mov_b32 s97, s9
    s_mov_b32 s98, 0x200000
    s_mov_b32 s99, 0x20000
    s_add_u32 s53, s51, 0
    s_add_u32 m0, s52, 140288
    s_nop 0
    buffer_load_dwordx4 v42, s[96:99], s53 offen lds
    s_add_u32 s53, s51, 8192
    s_add_u32 m0, s52, 141312
    s_nop 0
    buffer_load_dwordx4 v42, s[96:99], s53 offen lds
    s_mov_b32 s92, s10
    s_mov_b32 s93, s11
    s_mov_b32 s94, 0x1000
    s_mov_b32 s95, 0x20000
    buffer_load_dwordx2 v[40:41], v44, s[92:95], 0 offen
    s_mov_b32 s92, s12
    s_mov_b32 s93, s13
    s_mov_b32 s94, 0x200000
    s_mov_b32 s95, 0x20000
    buffer_load_dwordx4 a[224:227], v244, s[92:95], 0 offen
    buffer_load_dwordx2 a[228:229], v245, s[92:95], 0 offen
    buffer_load_dwordx4 a[232:235], v246, s[92:95], 0 offen
    buffer_load_dwordx2 a[230:231], v247, s[92:95], 0 offen
    s_mov_b32 s92, s24
    s_mov_b32 s93, s25
    s_mov_b32 s94, 0x400
    s_mov_b32 s95, 0x20000
    v_lshlrev_b32 v244, 7, v1
    buffer_load_dword v248, v244, s[92:95], 0 offen
    s_waitcnt vmcnt(10)
    v_lshrrev_b32 v8, 5, v1
    v_lshlrev_b32 v8, 2, v8
    v_bfe_u32 v9, v1, 2, 2
    v_add_u32 v8, v8, v9
    v_lshlrev_b32 v8, 7, v8
    v_bfe_u32 v9, v1, 4, 1
    v_lshl_add_u32 v8, v9, 5, v8
    v_and_b32 v9, 3, v1
    v_lshl_add_u32 v8, v9, 3, v8
    v_add_u32 v8, s56, v8
    v_lshlrev_b32 v9, 4, v1
    s_lshl_b32 s57, s61, 1
    s_mul_i32 s57, s57, 112
    s_mul_i32 s55, s54, 28
    s_add_u32 s57, s57, s55
    s_mul_i32 s55, s3, 7
    s_add_u32 s57, s57, s55
    s_lshl_b32 s57, s57, 10
    s_add_u32 s57, s57, 4194304
    ds_read_b64_tr_b16 v[64:65], v8 offset:0
    ds_read_b64_tr_b16 v[66:67], v8 offset:1024
    ds_read_b64_tr_b16 v[68:69], v8 offset:64
    ds_read_b64_tr_b16 v[70:71], v8 offset:1088
    ds_read_b64_tr_b16 v[72:73], v8 offset:2048
    ds_read_b64_tr_b16 v[74:75], v8 offset:3072
    ds_read_b64_tr_b16 v[76:77], v8 offset:2112
    ds_read_b64_tr_b16 v[78:79], v8 offset:3136
    ds_read_b64_tr_b16 v[80:81], v8 offset:4096
    ds_read_b64_tr_b16 v[82:83], v8 offset:5120
    ds_read_b64_tr_b16 v[84:85], v8 offset:4160
    ds_read_b64_tr_b16 v[86:87], v8 offset:5184
    ds_read_b64_tr_b16 v[88:89], v8 offset:6144
    ds_read_b64_tr_b16 v[90:91], v8 offset:7168
    ds_read_b64_tr_b16 v[92:93], v8 offset:6208
    ds_read_b64_tr_b16 v[94:95], v8 offset:7232
    ds_read_b64_tr_b16 v[96:97], v8 offset:8192
    ds_read_b64_tr_b16 v[98:99], v8 offset:9216
    ds_read_b64_tr_b16 v[100:101], v8 offset:8256
    ds_read_b64_tr_b16 v[102:103], v8 offset:9280
    ds_read_b64_tr_b16 v[104:105], v8 offset:10240
    ds_read_b64_tr_b16 v[106:107], v8 offset:11264
    ds_read_b64_tr_b16 v[108:109], v8 offset:10304
    ds_read_b64_tr_b16 v[110:111], v8 offset:11328
    ds_read_b64_tr_b16 v[112:113], v8 offset:12288
    ds_read_b64_tr_b16 v[114:115], v8 offset:13312
    ds_read_b64_tr_b16 v[116:117], v8 offset:12352
    ds_read_b64_tr_b16 v[118:119], v8 offset:13376
    s_waitcnt lgkmcnt(15)
    s_add_u32 s55, s57, 0
    buffer_store_dwordx4 v[64:67], v9, s[32:35], s55 offen sc1
    s_add_u32 s55, s57, 114688
    buffer_store_dwordx4 v[68:71], v9, s[32:35], s55 offen sc1
    s_add_u32 s55, s57, 1024
    buffer_store_dwordx4 v[72:75], v9, s[32:35], s55 offen sc1
    s_add_u32 s55, s57, 115712
    buffer_store_dwordx4 v[76:79], v9, s[32:35], s55 offen sc1
    s_add_u32 s55, s57, 2048
    buffer_store_dwordx4 v[80:83], v9, s[32:35], s55 offen sc1
    s_add_u32 s55, s57, 116736
    buffer_store_dwordx4 v[84:87], v9, s[32:35], s55 offen sc1
    s_waitcnt lgkmcnt(14)
    s_add_u32 s55, s57, 3072
    buffer_store_dwordx4 v[88:91], v9, s[32:35], s55 offen sc1
    s_waitcnt lgkmcnt(12)
    s_add_u32 s55, s57, 117760
    buffer_store_dwordx4 v[92:95], v9, s[32:35], s55 offen sc1
    s_waitcnt lgkmcnt(10)
    s_add_u32 s55, s57, 4096
    buffer_store_dwordx4 v[96:99], v9, s[32:35], s55 offen sc1
    s_waitcnt lgkmcnt(8)
    s_add_u32 s55, s57, 118784
    buffer_store_dwordx4 v[100:103], v9, s[32:35], s55 offen sc1
    s_waitcnt lgkmcnt(6)
    s_add_u32 s55, s57, 5120
    buffer_store_dwordx4 v[104:107], v9, s[32:35], s55 offen sc1
    s_waitcnt lgkmcnt(4)
    s_add_u32 s55, s57, 119808
    buffer_store_dwordx4 v[108:111], v9, s[32:35], s55 offen sc1
    s_waitcnt lgkmcnt(2)
    s_add_u32 s55, s57, 6144
    buffer_store_dwordx4 v[112:115], v9, s[32:35], s55 offen sc1
    s_waitcnt lgkmcnt(0)
    s_add_u32 s55, s57, 120832
    buffer_store_dwordx4 v[116:119], v9, s[32:35], s55 offen sc1
    s_waitcnt vmcnt(0)
    s_barrier
    v_readfirstlane_b32 s16, v62
    s_nop 3
    s_add_u32 s16, s16, 2654435769
    s_cmp_lg_u32 s3, 0
    s_cbranch_scc1 Lw023
    s_lshl_b32 s55, s61, 2
    s_add_u32 s55, s55, s54
    s_lshl_b32 s55, s55, 7
    s_add_u32 s55, s55, 14876672
    v_mov_b32 v10, 0
    v_writelane_b32 v10, s55, 0
    v_mov_b32 v11, s16
    s_mov_b64 exec, 1
    buffer_store_dword v11, v10, s[32:35], 0 offen sc1
    s_mov_b64 exec, -1
Lw023:
    v_lshlrev_b32 v208, 16, v32
    v_and_b32 v209, 0xffff0000, v32
    v_lshlrev_b32 v210, 16, v33
    v_and_b32 v211, 0xffff0000, v33
    v_lshlrev_b32 v212, 16, v34
    v_and_b32 v213, 0xffff0000, v34
    v_lshlrev_b32 v214, 16, v35
    v_and_b32 v215, 0xffff0000, v35
    v_lshlrev_b32 v216, 16, v36
    v_and_b32 v217, 0xffff0000, v36
    v_lshlrev_b32 v218, 16, v37
    v_and_b32 v219, 0xffff0000, v37
    v_lshlrev_b32 v220, 16, v38
    v_and_b32 v221, 0xffff0000, v38
    v_lshlrev_b32 v222, 16, v39
    v_and_b32 v223, 0xffff0000, v39
    v_add_f32 v224, v208, v209
    v_add_f32 v225, v216, v217
    v_add_f32 v224, v224, v210
    v_add_f32 v225, v225, v218
    v_add_f32 v224, v224, v211
    v_add_f32 v225, v225, v219
    v_add_f32 v224, v224, v212
    v_add_f32 v225, v225, v220
    v_add_f32 v224, v224, v213
    v_add_f32 v225, v225, v221
    v_add_f32 v224, v224, v214
    v_add_f32 v225, v225, v222
    v_add_f32 v224, v224, v215
    v_add_f32 v225, v225, v223
    s_nop 0
    v_add_f32_dpp v224, v224, v224 quad_perm:[1,0,3,2] row_mask:0xf bank_mask:0xf
    v_add_f32_dpp v225, v225, v225 quad_perm:[1,0,3,2] row_mask:0xf bank_mask:0xf
    s_nop 0
    v_add_f32_dpp v224, v224, v224 quad_perm:[2,3,0,1] row_mask:0xf bank_mask:0xf
    v_add_f32_dpp v225, v225, v225 quad_perm:[2,3,0,1] row_mask:0xf bank_mask:0xf
    s_nop 0
    v_add_f32_dpp v224, v224, v224 row_half_mirror row_mask:0xf bank_mask:0xf
    v_add_f32_dpp v225, v225, v225 row_half_mirror row_mask:0xf bank_mask:0xf
    s_nop 0
    v_add_f32_dpp v224, v224, v224 row_mirror row_mask:0xf bank_mask:0xf
    v_add_f32_dpp v225, v225, v225 row_mirror row_mask:0xf bank_mask:0xf
    v_mov_b32 v226, v224
    v_mov_b32 v227, v225
    s_nop 0
    v_permlane16_swap_b32 v224, v226
    v_permlane16_swap_b32 v225, v227
    v_add_f32 v224, v224, v226
    v_add_f32 v225, v225, v227
    v_mov_b32 v226, v224
    v_mov_b32 v227, v225
    s_nop 0
    v_permlane32_swap_b32 v224, v226
    v_permlane32_swap_b32 v225, v227
    v_add_f32 v224, v224, v226
    v_add_f32 v225, v225, v227
    v_mul_f32 v224, 0x3b000000, v224
    v_mul_f32 v225, 0x3b000000, v225
    v_sub_f32 v208, v208, v224
    v_sub_f32 v216, v216, v225
    v_sub_f32 v209, v209, v224
    v_sub_f32 v217, v217, v225
    v_sub_f32 v210, v210, v224
    v_sub_f32 v218, v218, v225
    v_sub_f32 v211, v211, v224
    v_sub_f32 v219, v219, v225
    v_sub_f32 v212, v212, v224
    v_sub_f32 v220, v220, v225
    v_sub_f32 v213, v213, v224
    v_sub_f32 v221, v221, v225
    v_sub_f32 v214, v214, v224
    v_sub_f32 v222, v222, v225
    v_sub_f32 v215, v215, v224
    v_sub_f32 v223, v223, v225
    v_mul_f32 v228, v208, v208
    v_mul_f32 v229, v216, v216
    v_fmac_f32 v228, v209, v209
    v_fmac_f32 v229, v217, v217
    v_fmac_f32 v228, v210, v210
    v_fmac_f32 v229, v218, v218
    v_fmac_f32 v228, v211, v211
    v_fmac_f32 v229, v219, v219
    v_fmac_f32 v228, v212, v212
    v_fmac_f32 v229, v220, v220
    v_fmac_f32 v228, v213, v213
    v_fmac_f32 v229, v221, v221
    v_fmac_f32 v228, v214, v214
    v_fmac_f32 v229, v222, v222
    v_fmac_f32 v228, v215, v215
    v_fmac_f32 v229, v223, v223
    s_nop 0
    v_add_f32_dpp v228, v228, v228 quad_perm:[1,0,3,2] row_mask:0xf bank_mask:0xf
    v_add_f32_dpp v229, v229, v229 quad_perm:[1,0,3,2] row_mask:0xf bank_mask:0xf
    s_nop 0
    v_add_f32_dpp v228, v228, v228 quad_perm:[2,3,0,1] row_mask:0xf bank_mask:0xf
    v_add_f32_dpp v229, v229, v229 quad_perm:[2,3,0,1] row_mask:0xf bank_mask:0xf
    s_nop 0
    v_add_f32_dpp v228, v228, v228 row_half_mirror row_mask:0xf bank_mask:0xf
    v_add_f32_dpp v229, v229, v229 row_half_mirror row_mask:0xf bank_mask:0xf
    s_nop 0
    v_add_f32_dpp v228, v228, v228 row_mirror row_mask:0xf bank_mask:0xf
    v_add_f32_dpp v229, v229, v229 row_mirror row_mask:0xf bank_mask:0xf
    v_mov_b32 v226, v228
    v_mov_b32 v227, v229
    s_nop 0
    v_permlane16_swap_b32 v228, v226
    v_permlane16_swap_b32 v229, v227
    v_add_f32 v228, v228, v226
    v_add_f32 v229, v229, v227
    v_mov_b32 v226, v228
    v_mov_b32 v227, v229
    s_nop 0
    v_permlane32_swap_b32 v228, v226
    v_permlane32_swap_b32 v229, v227
    v_add_f32 v228, v228, v226
    v_add_f32 v229, v229, v227
    v_mul_f32 v228, 0x3b000000, v228
    v_mul_f32 v229, 0x3b000000, v229
    v_and_b32 v226, 1, v1
    v_cmp_eq_u32 vcc, 1, v226
    s_nop 1
    v_cndmask_b32 v224, v224, v225, vcc
    v_cndmask_b32 v228, v228, v229, vcc
    v_cvt_pk_bf16_f32 v232, v224, v228
    v_and_b32 v227, 0xffff0000, v232
    v_add_f32 v227, 0x3727c5ac, v227
    v_cvt_pk_bf16_f32 v227, v227, v227
    v_lshlrev_b32 v227, 16, v227
    v_sqrt_f32 v227, v227
    s_nop 0
    v_cvt_pk_bf16_f32 v227, v227, v227
    v_and_b32 v232, 0xffff, v232
    v_and_b32 v227, 0xffff0000, v227
    v_or_b32 v232, v232, v227
    v_mov_b32 v233, s16
    v_mov_b32 v60, v232
    v_mov_b32 v61, v233
    s_lshl_b32 s59, s58, 6
    s_add_u32 s59, s59, 15204352
    v_lshlrev_b32 v59, 3, v1
    s_mov_b64 exec, 3
    buffer_store_dwordx2 v[60:61], v59, s[32:35], s59 offen sc1
    s_mov_b64 exec, -1
    s_barrier
    v_lshrrev_b32 v42, 4, v1
    v_lshlrev_b32 v42, 3, v42
    v_bfe_u32 v43, v1, 2, 2
    v_add_u32 v42, v42, v43
    v_lshlrev_b32 v42, 7, v42
    v_and_b32 v43, 3, v1
    v_lshl_add_u32 v42, v43, 3, v42
    s_lshl_b32 s59, s3, 5
    v_add_u32 v42, s59, v42
    v_add_u32 v43, 131072, v42
    v_add_u32 v44, 140288, v42
    ds_read_b64_tr_b16 v[188:189], v43 offset:512
    ds_read_b64_tr_b16 v[190:191], v43 offset:1024
    ds_read_b64_tr_b16 v[192:193], v43 offset:1536
    ds_read_b64_tr_b16 v[200:201], v44 offset:0
    ds_read_b64_tr_b16 v[202:203], v44 offset:512
    ds_read_b64_tr_b16 v[194:195], v43 offset:4608
    ds_read_b64_tr_b16 v[196:197], v43 offset:5120
    ds_read_b64_tr_b16 v[198:199], v43 offset:5632
    ds_read_b64_tr_b16 v[204:205], v44 offset:4096
    ds_read_b64_tr_b16 v[206:207], v44 offset:4608
    v_lshlrev_b32 v54, 16, v40
    v_and_b32 v55, 0xffff0000, v40
    v_lshlrev_b32 v56, 16, v41
    v_and_b32 v57, 0xffff0000, v41
    v_lshlrev_b32 v42, 12, v58
    v_lshrrev_b32 v43, 4, v1
    v_lshl_add_u32 v42, v43, 4, v42
    s_lshl_b32 s57, s48, 1
    s_add_u32 s57, s57, 0
    s_waitcnt lgkmcnt(5)
    v_and_b32 v209, 0xffff0000, v188
    v_lshlrev_b32 v210, 16, v189
    v_and_b32 v211, 0xffff0000, v189
    v_lshlrev_b32 v212, 16, v190
    v_and_b32 v213, 0xffff0000, v190
    v_lshlrev_b32 v214, 16, v191
    v_and_b32 v215, 0xffff0000, v191
    v_lshlrev_b32 v216, 16, v192
    v_and_b32 v217, 0xffff0000, v192
    v_lshlrev_b32 v218, 16, v193
    v_and_b32 v219, 0xffff0000, v193
    v_lshlrev_b32 v220, 16, v200
    v_and_b32 v221, 0xffff0000, v200
    v_lshlrev_b32 v222, 16, v201
    v_and_b32 v223, 0xffff0000, v201
    v_lshlrev_b32 v224, 16, v202
    v_and_b32 v225, 0xffff0000, v202
    v_lshlrev_b32 v226, 16, v203
    v_and_b32 v227, 0xffff0000, v203
    v_mul_f32 v228, v209, v57
    v_mul_f32 v229, v210, v57
    v_mul_f32 v230, v211, v57
    v_mul_f32 v231, v212, v57
    v_mul_f32 v232, v213, v57
    v_mul_f32 v233, v214, v57
    v_mul_f32 v234, v215, v57
    v_mul_f32 v235, v216, v57
    v_fmac_f32 v228, v210, v56
    v_fmac_f32 v229, v211, v56
    v_fmac_f32 v230, v212, v56
    v_fmac_f32 v231, v213, v56
    v_fmac_f32 v232, v214, v56
    v_fmac_f32 v233, v215, v56
    v_fmac_f32 v234, v216, v56
    v_fmac_f32 v235, v217, v56
    v_fmac_f32 v228, v211, v55
    v_fmac_f32 v229, v212, v55
    v_fmac_f32 v230, v213, v55
    v_fmac_f32 v231, v214, v55
    v_fmac_f32 v232, v215, v55
    v_fmac_f32 v233, v216, v55
    v_fmac_f32 v234, v217, v55
    v_fmac_f32 v235, v218, v55
    v_fmac_f32 v228, v212, v54
    v_fmac_f32 v229, v213, v54
    v_fmac_f32 v230, v214, v54
    v_fmac_f32 v231, v215, v54
    v_fmac_f32 v232, v216, v54
    v_fmac_f32 v233, v217, v54
    v_fmac_f32 v234, v218, v54
    v_fmac_f32 v235, v219, v54
    v_mul_f32 v228, v228, v220
    v_mul_f32 v229, v229, v221
    v_mul_f32 v230, v230, v222
    v_mul_f32 v231, v231, v223
    v_mul_f32 v232, v232, v224
    v_mul_f32 v233, v233, v225
    v_mul_f32 v234, v234, v226
    v_mul_f32 v235, v235, v227
    v_cvt_pk_bf16_f32 v236, v228, v229
    v_cvt_pk_bf16_f32 v237, v230, v231
    v_cvt_pk_bf16_f32 v238, v232, v233
    v_cvt_pk_bf16_f32 v239, v234, v235
    s_waitcnt lgkmcnt(0)
    v_and_b32 v209, 0xffff0000, v194
    v_lshlrev_b32 v210, 16, v195
    v_and_b32 v211, 0xffff0000, v195
    v_lshlrev_b32 v212, 16, v196
    v_and_b32 v213, 0xffff0000, v196
    v_lshlrev_b32 v214, 16, v197
    v_and_b32 v215, 0xffff0000, v197
    v_lshlrev_b32 v216, 16, v198
    v_and_b32 v217, 0xffff0000, v198
    v_lshlrev_b32 v218, 16, v199
    v_and_b32 v219, 0xffff0000, v199
    v_lshlrev_b32 v220, 16, v204
    v_and_b32 v221, 0xffff0000, v204
    v_lshlrev_b32 v222, 16, v205
    v_and_b32 v223, 0xffff0000, v205
    v_lshlrev_b32 v224, 16, v206
    v_and_b32 v225, 0xffff0000, v206
    v_lshlrev_b32 v226, 16, v207
    v_and_b32 v227, 0xffff0000, v207
    v_mul_f32 v228, v209, v57
    v_mul_f32 v229, v210, v57
    v_mul_f32 v230, v211, v57
    v_mul_f32 v231, v212, v57
    v_mul_f32 v232, v213, v57
    v_mul_f32 v233, v214, v57
    v_mul_f32 v234, v215, v57
    v_mul_f32 v235, v216, v57
    v_fmac_f32 v228, v210, v56
    v_fmac_f32 v229, v211, v56
    v_fmac_f32 v230, v212, v56
    v_fmac_f32 v231, v213, v56
    v_fmac_f32 v232, v214, v56
    v_fmac_f32 v233, v215, v56
    v_fmac_f32 v234, v216, v56
    v_fmac_f32 v235, v217, v56
    v_fmac_f32 v228, v211, v55
    v_fmac_f32 v229, v212, v55
    v_fmac_f32 v230, v213, v55
    v_fmac_f32 v231, v214, v55
    v_fmac_f32 v232, v215, v55
    v_fmac_f32 v233, v216, v55
    v_fmac_f32 v234, v217, v55
    v_fmac_f32 v235, v218, v55
    v_fmac_f32 v228, v212, v54
    v_fmac_f32 v229, v213, v54
    v_fmac_f32 v230, v214, v54
    v_fmac_f32 v231, v215, v54
    v_fmac_f32 v232, v216, v54
    v_fmac_f32 v233, v217, v54
    v_fmac_f32 v234, v218, v54
    v_fmac_f32 v235, v219, v54
    v_mul_f32 v228, v228, v220
    v_mul_f32 v229, v229, v221
    v_mul_f32 v230, v230, v222
    v_mul_f32 v231, v231, v223
    v_mul_f32 v232, v232, v224
    v_mul_f32 v233, v233, v225
    v_mul_f32 v234, v234, v226
    v_mul_f32 v235, v235, v227
    v_cvt_pk_bf16_f32 v240, v228, v229
    v_cvt_pk_bf16_f32 v241, v230, v231
    v_cvt_pk_bf16_f32 v242, v232, v233
    v_cvt_pk_bf16_f32 v243, v234, v235
    buffer_store_dwordx4 v[236:239], v42, s[32:35], s57 offen offset:0 sc1
    buffer_store_dwordx4 v[240:243], v42, s[32:35], s57 offen offset:64 sc1
    v_accvgpr_read_b32 v188, a224
    v_accvgpr_read_b32 v189, a225
    v_accvgpr_read_b32 v190, a226
    v_accvgpr_read_b32 v191, a227
    v_accvgpr_read_b32 v192, a228
    v_accvgpr_read_b32 v193, a229
    v_accvgpr_read_b32 v194, a230
    v_accvgpr_read_b32 v195, a231
    v_accvgpr_read_b32 v196, a232
    v_accvgpr_read_b32 v197, a233
    v_accvgpr_read_b32 v198, a234
    v_accvgpr_read_b32 v199, a235
    v_cmp_eq_u32 vcc, 0, v0
    s_nop 1
    v_cndmask_b32_e64 v192, v192, 0, vcc
    v_cndmask_b32_e64 v193, v193, 0, vcc
    v_accvgpr_write_b32 a192, v188
    v_accvgpr_write_b32 a193, v189
    v_accvgpr_write_b32 a194, v190
    v_accvgpr_write_b32 a195, v191
    v_alignbit_b32 v200, v188, v193, 16
    v_alignbit_b32 v201, v189, v188, 16
    v_alignbit_b32 v202, v190, v189, 16
    v_alignbit_b32 v203, v191, v190, 16
    v_accvgpr_write_b32 a200, v193
    v_accvgpr_write_b32 a201, v188
    v_accvgpr_write_b32 a202, v189
    v_accvgpr_write_b32 a203, v190
    v_accvgpr_write_b32 a196, v200
    v_accvgpr_write_b32 a197, v201
    v_accvgpr_write_b32 a198, v202
    v_accvgpr_write_b32 a199, v203
    v_accvgpr_write_b32 a205, v200
    v_accvgpr_write_b32 a206, v201
    v_accvgpr_write_b32 a207, v202
    v_alignbit_b32 v200, v193, v192, 16
    v_accvgpr_write_b32 a204, v200
    v_cndmask_b32_e64 v194, v194, 0, vcc
    v_cndmask_b32_e64 v195, v195, 0, vcc
    v_accvgpr_write_b32 a208, v196
    v_accvgpr_write_b32 a209, v197
    v_accvgpr_write_b32 a210, v198
    v_accvgpr_write_b32 a211, v199
    v_alignbit_b32 v200, v196, v195, 16
    v_alignbit_b32 v201, v197, v196, 16
    v_alignbit_b32 v202, v198, v197, 16
    v_alignbit_b32 v203, v199, v198, 16
    v_accvgpr_write_b32 a216, v195
    v_accvgpr_write_b32 a217, v196
    v_accvgpr_write_b32 a218, v197
    v_accvgpr_write_b32 a219, v198
    v_accvgpr_write_b32 a212, v200
    v_accvgpr_write_b32 a213, v201
    v_accvgpr_write_b32 a214, v202
    v_accvgpr_write_b32 a215, v203
    v_accvgpr_write_b32 a221, v200
    v_accvgpr_write_b32 a222, v201
    v_accvgpr_write_b32 a223, v202
    v_alignbit_b32 v200, v195, v194, 16
    v_accvgpr_write_b32 a220, v200
    s_waitcnt vmcnt(0)
    s_and_b32 s59, s2, 7
    s_lshl_b32 s59, s59, 2
    s_add_u32 s59, s59, s3
    s_lshl_b32 s59, s59, 5
    s_lshr_b32 s60, s2, 3
    s_add_u32 s59, s59, s60
    s_lshl_b32 s59, s59, 7
    s_add_u32 s59, s59, 14745600
    s_lshl_b32 s53, s2, 7
    s_lshl_b32 s60, s3, 2
    s_add_u32 s53, s53, s60
    s_add_u32 s53, s53, 14893056
    v_mov_b32 v42, 0
    v_writelane_b32 v42, s59, 0
    v_writelane_b32 v42, s53, 1
    v_mov_b32 v43, s16
    s_mov_b64 exec, 3
    buffer_store_dword v43, v42, s[32:35], 0 offen sc1
    s_mov_b64 exec, -1
    s_barrier
    v_lshlrev_b32 v8, 4, v0
    v_add_u32 v9, 32800, v8
    ds_write_b128 v9, a[192:195] offset:0
    ds_write_b128 v9, a[196:199] offset:4160
    ds_write_b128 v9, a[200:203] offset:8320
    ds_write_b128 v9, a[204:207] offset:12480
    ds_write_b128 v9, a[208:211] offset:16640
    ds_write_b128 v9, a[212:215] offset:20800
    ds_write_b128 v9, a[216:219] offset:24960
    ds_write_b128 v9, a[220:223] offset:29120
    v_mov_b64 v[12:13], 0
    v_mov_b64 v[14:15], 0
    v_lshrrev_b32 v10, 1, v0
    v_and_b32 v11, 3, v10
    v_mul_u32_u24 v11, 4160, v11
    v_bfe_u32 v10, v0, 3, 1
    v_mul_u32_u24 v10, 16640, v10
    v_add_u32 v11, v11, v10
    v_and_b32 v10, 1, v0
    v_lshl_add_u32 v11, v10, 4, v11
    v_add_u32 v11, 32768, v11
    v_subrev_u32 v10, 16, v0
    v_and_b32 v16, 31, v10
    v_lshlrev_b32 v16, 4, v16
    v_bfe_u32 v10, v10, 5, 1
    v_mul_u32_u24 v10, 4608, v10
    v_add_u32 v16, v16, v10
    v_cmp_gt_u32 vcc, 16, v0
    s_nop 1
    v_cndmask_b32 v11, v16, v11, vcc
    v_cmp_gt_u32 vcc, 80, v0
    s_nop 1
    s_and_saveexec_b64 s[76:77], vcc
    s_cbranch_execz Lcz24
    ds_write_b128 v11, v[12:15]
Lcz24:
    s_mov_b64 exec, s[76:77]
    s_cmp_lg_u32 s3, 0
    s_cbranch_scc1 Lw025
    s_lshr_b32 s73, s2, 5
    s_lshl_b32 s73, s73, 2
    s_bfe_u32 s74, s2, 0x20003
    s_add_u32 s73, s73, s74
    s_lshl_b32 s73, s73, 12
    s_add_u32 s73, s73, 14745600
    v_and_b32 v34, 31, v1
    v_lshl_add_u32 v34, v34, 7, s73
    v_and_b32 v35, 31, v1
    v_lshlrev_b32 v35, 7, v35
    v_add_u32 v35, 14876672, v35
    s_sleep 32
    buffer_load_dword v38, v35, s[32:35], 0 offen sc1
    s_waitcnt vmcnt(0)
    s_mov_b32 s17, 0
Lpc26:
    v_cmp_ne_u32 vcc, s16, v38
    s_nop 1
    s_mov_b64 s[90:91], vcc
    s_cmp_eq_u64 s[90:91], 0
    s_cbranch_scc1 Lpd27
    s_add_u32 s17, s17, 1
    s_cmp_gt_u32 s17, 100000
    s_cbranch_scc1 Lpd27
    s_sleep 16
    buffer_load_dword v38, v35, s[32:35], 0 offen sc1
    s_waitcnt vmcnt(0)
    s_branch Lpc26
Lpd27:
    buffer_load_dword v36, v34, s[32:35], 0 offen sc1
    s_waitcnt vmcnt(0)
    s_mov_b32 s17, 0
Lpc28:
    v_cmp_ne_u32 vcc, s16, v36
    s_nop 1
    s_mov_b64 s[90:91], vcc
    s_cmp_eq_u64 s[90:91], 0
    s_cbranch_scc1 Lpd29
    s_add_u32 s17, s17, 1
    s_cmp_gt_u32 s17, 100000
    s_cbranch_scc1 Lpd29
    s_sleep 16
    buffer_load_dword v36, v34, s[32:35], 0 offen sc1
    s_waitcnt vmcnt(0)
    s_branch Lpc28
Lpd29:
    s_lshl_b32 s73, s2, 13
    s_add_u32 s73, s73, 0
    v_lshlrev_b32 v37, 4, v1
    buffer_load_dwordx4 a[224:227], v37, s[32:35], s73 offen offset:0 sc1
    buffer_load_dwordx4 a[228:231], v37, s[32:35], s73 offen offset:1024 sc1
    buffer_load_dwordx4 a[232:235], v37, s[32:35], s73 offen offset:2048 sc1
    buffer_load_dwordx4 a[236:239], v37, s[32:35], s73 offen offset:3072 sc1
    s_add_u32 s73, s73, 4096
    buffer_load_dwordx4 a[240:243], v37, s[32:35], s73 offen offset:0 sc1
    buffer_load_dwordx4 a[244:247], v37, s[32:35], s73 offen offset:1024 sc1
    buffer_load_dwordx4 a[248:251], v37, s[32:35], s73 offen offset:2048 sc1
    buffer_load_dwordx4 a[252:255], v37, s[32:35], s73 offen offset:3072 sc1
Lw025:
    s_barrier
    s_mov_b32 s100, 1
    s_mov_b32 s98, 6291456
    s_mov_b32 s97, 0
    v_mov_b32 v232, 0x20000000
    v_lshlrev_b32 v240, 4, v1
    v_add_u32 v241, 114688, v240
    s_add_u32 s87, s83, s84
    s_add_u32 s84, s84, 4096
    s_cmp_eq_u32 s84, 28672
    s_cselect_b32 s84, 0, s84
    buffer_load_dwordx4 a[0:3], v240, s[32:35], s87 offen offset:0 sc1
    buffer_load_dwordx4 a[4:7], v241, s[32:35], s87 offen offset:0 sc1
    buffer_load_dwordx4 a[8:11], v240, s[32:35], s87 offen offset:1024 sc1
    buffer_load_dwordx4 a[12:15], v241, s[32:35], s87 offen offset:1024 sc1
    buffer_load_dwordx4 a[16:19], v240, s[32:35], s87 offen offset:2048 sc1
    buffer_load_dwordx4 a[20:23], v241, s[32:35], s87 offen offset:2048 sc1
    buffer_load_dwordx4 a[24:27], v240, s[32:35], s87 offen offset:3072 sc1
    buffer_load_dwordx4 a[28:31], v241, s[32:35], s87 offen offset:3072 sc1
    s_add_u32 s87, s83, s84
    s_add_u32 s84, s84, 4096
    s_cmp_eq_u32 s84, 28672
    s_cselect_b32 s84, 0, s84
    buffer_load_dwordx4 a[32:35], v240, s[32:35], s87 offen offset:0 sc1
    buffer_load_dwordx4 a[36:39], v241, s[32:35], s87 offen offset:0 sc1
    buffer_load_dwordx4 a[40:43], v240, s[32:35], s87 offen offset:1024 sc1
    buffer_load_dwordx4 a[44:47], v241, s[32:35], s87 offen offset:1024 sc1
    s_cmp_lg_u32 s3, 0
    s_cbranch_scc1 Lw030
    v_lshlrev_b32 v8, 4, v1
    s_waitcnt vmcnt(12)
    ds_write_b128 v8, a[224:227] offset:512
    ds_write_b128 v8, a[228:231] offset:1536
    ds_write_b128 v8, a[232:235] offset:2560
    ds_write_b128 v8, a[236:239] offset:3584
    ds_write_b128 v8, a[240:243] offset:5120
    ds_write_b128 v8, a[244:247] offset:6144
    ds_write_b128 v8, a[248:251] offset:7168
    ds_write_b128 v8, a[252:255] offset:8192
Lw030:
Ljoin:
    s_lshr_b32 s76, s3, 1
    s_and_b32 s77, s3, 1
    v_bfe_u32 v4, v1, 2, 2
    v_mul_u32_u24 v2, 4160, v4
    v_and_b32 v4, 3, v1
    v_lshl_add_u32 v2, v4, 3, v2
    v_lshrrev_b32 v4, 4, v1
    v_lshlrev_b32 v4, 4, v4
    v_sub_u32 v2, v2, v4
    s_mul_i32 s78, s76, 16640
    s_lshl_b32 s79, s77, 8
    s_add_u32 s78, s78, s79
    s_add_u32 s78, s78, 32824
    v_add_u32 v2, s78, v2
    v_and_b32 v4, 15, v1
    v_lshlrev_b32 v3, 5, v4
    v_lshrrev_b32 v4, 4, v1
    v_lshl_add_u32 v3, v4, 4, v3
    s_mul_i32 s78, s76, 4608
    s_lshl_b32 s79, s77, 8
    s_sub_u32 s78, s78, s79
    s_add_u32 s78, s78, 288
    v_add_u32 v3, s78, v3
    v_mov_b64 v[8:9], 0
    v_mov_b64 v[10:11], 0
    v_mov_b64 v[12:13], 0
    v_mov_b64 v[14:15], 0
    v_mov_b64 v[16:17], 0
    v_mov_b64 v[18:19], 0
    v_mov_b64 v[20:21], 0
    v_mov_b64 v[22:23], 0
    v_mov_b64 v[24:25], 0
    v_mov_b64 v[26:27], 0
    v_mov_b64 v[28:29], 0
    v_mov_b64 v[30:31], 0
    v_mov_b64 v[32:33], 0
    v_mov_b64 v[34:35], 0
    v_mov_b64 v[36:37], 0
    v_mov_b64 v[38:39], 0
    s_waitcnt lgkmcnt(0)
    s_barrier
    s_cmp_lg_u32 s100, 0
    s_cbranch_scc1 Ltp31
    s_getreg_b32 s90, hwreg(HW_REG_IB_STS)
    s_and_b32 s91, s90, 15
    s_lshr_b32 s90, s90, 18
    s_and_b32 s90, s90, 0x30
    s_or_b32 s90, s90, s91
    s_cmp_gt_u32 s90, 0
    s_cbranch_scc1 Ltp31
    s_lshr_b32 s69, s63, 7
    s_lshl_b32 s69, s69, 6
    s_lshr_b32 s72, s64, 7
    s_lshl_b32 s72, s72, 2
    s_add_u32 s69, s69, s72
    s_add_u32 s69, s69, s3
    s_lshl_b32 s69, s69, 7
    s_add_u32 s69, s69, 14942208
    v_mov_b32 v4, 0
    v_writelane_b32 v4, s69, 0
    v_mov_b32 v5, s16
    s_mov_b64 exec, 1
    buffer_store_dword v5, v4, s[32:35], 0 offen sc1
    s_mov_b64 exec, -1
    s_mov_b32 s100, 1
Ltp31:
    ds_read_b64_tr_b16 v[64:65], v2 offset:8
    ds_read_b64_tr_b16 v[66:67], v2 offset:0
    ds_read_b128 v[96:99], v3 offset:192
    ds_read_b64_tr_b16 v[68:69], v2 offset:520
    ds_read_b64_tr_b16 v[70:71], v2 offset:512
    ds_read_b128 v[100:103], v3 offset:704
    ds_read_b64_tr_b16 v[72:73], v2 offset:1032
    ds_read_b64_tr_b16 v[74:75], v2 offset:1024
    ds_read_b128 v[104:107], v3 offset:1216
    ds_read_b64_tr_b16 v[76:77], v2 offset:1544
    ds_read_b64_tr_b16 v[78:79], v2 offset:1536
    ds_read_b128 v[108:111], v3 offset:1728
    ds_read_b64_tr_b16 v[80:81], v2 offset:2056
    ds_read_b64_tr_b16 v[82:83], v2 offset:2048
    ds_read_b128 v[112:115], v3 offset:2240
    ds_read_b64_tr_b16 v[84:85], v2 offset:2568
    ds_read_b64_tr_b16 v[86:87], v2 offset:2560
    ds_read_b128 v[116:119], v3 offset:2752
    ds_read_b64_tr_b16 v[88:89], v2 offset:3080
    ds_read_b64_tr_b16 v[90:91], v2 offset:3072
    ds_read_b128 v[120:123], v3 offset:3264
    ds_read_b64_tr_b16 v[92:93], v2 offset:3592
    ds_read_b64_tr_b16 v[94:95], v2 offset:3584
    ds_read_b128 v[124:127], v3 offset:3776
    s_waitcnt lgkmcnt(15)
    v_mfma_f32_16x16x32_bf16 v[8:11], v[64:67], v[96:99], v[8:11]
    v_mfma_f32_16x16x32_bf16 v[12:15], v[64:67], v[100:103], v[12:15]
    ds_read_b64_tr_b16 v[128:129], v2 offset:72
    v_mfma_f32_16x16x32_bf16 v[12:15], v[68:71], v[96:99], v[12:15]
    ds_read_b64_tr_b16 v[130:131], v2 offset:64
    v_mfma_f32_16x16x32_bf16 v[16:19], v[68:71], v[100:103], v[16:19]
    ds_read_b128 v[160:163], v3 offset:128
    v_mfma_f32_16x16x32_bf16 v[16:19], v[64:67], v[104:107], v[16:19]
    ds_read_b64_tr_b16 v[132:133], v2 offset:584
    buffer_load_dwordx4 a[48:51], v240, s[32:35], s87 offen offset:2048 sc1
    v_mfma_f32_16x16x32_bf16 v[20:23], v[68:71], v[104:107], v[20:23]
    v_mfma_f32_16x16x32_bf16 v[16:19], v[72:75], v[96:99], v[16:19]
    ds_read_b64_tr_b16 v[134:135], v2 offset:576
    v_mfma_f32_16x16x32_bf16 v[20:23], v[72:75], v[100:103], v[20:23]
    ds_read_b128 v[164:167], v3 offset:640
    v_mfma_f32_16x16x32_bf16 v[24:27], v[72:75], v[104:107], v[24:27]
    ds_read_b64_tr_b16 v[136:137], v2 offset:1096
    buffer_load_dwordx4 a[52:55], v241, s[32:35], s87 offen offset:2048 sc1
    s_waitcnt lgkmcnt(15)
    v_mfma_f32_16x16x32_bf16 v[20:23], v[64:67], v[108:111], v[20:23]
    ds_read_b64_tr_b16 v[138:139], v2 offset:1088
    v_mfma_f32_16x16x32_bf16 v[24:27], v[68:71], v[108:111], v[24:27]
    v_mfma_f32_16x16x32_bf16 v[28:31], v[72:75], v[108:111], v[28:31]
    ds_read_b128 v[168:171], v3 offset:1152
    v_mfma_f32_16x16x32_bf16 v[20:23], v[76:79], v[96:99], v[20:23]
    ds_read_b64_tr_b16 v[140:141], v2 offset:1608
    s_cmp_lg_u32 s100, 0
    s_cbranch_scc1 Ltp32
    s_getreg_b32 s90, hwreg(HW_REG_IB_STS)
    s_and_b32 s91, s90, 15
    s_lshr_b32 s90, s90, 18
    s_and_b32 s90, s90, 0x30
    s_or_b32 s90, s90, s91
    s_cmp_gt_u32 s90, 2
    s_cbranch_scc1 Ltp32
    s_lshr_b32 s69, s63, 7
    s_lshl_b32 s69, s69, 6
    s_lshr_b32 s72, s64, 7
    s_lshl_b32 s72, s72, 2
    s_add_u32 s69, s69, s72
    s_add_u32 s69, s69, s3
    s_lshl_b32 s69, s69, 7
    s_add_u32 s69, s69, 14942208
    v_mov_b32 v4, 0
    v_writelane_b32 v4, s69, 0
    v_mov_b32 v5, s16
    s_mov_b64 exec, 1
    buffer_store_dword v5, v4, s[32:35], 0 offen sc1
    s_mov_b64 exec, -1
    s_mov_b32 s100, 1
Ltp32:
    v_mfma_f32_16x16x32_bf16 v[24:27], v[76:79], v[100:103], v[24:27]
    ds_read_b64_tr_b16 v[142:143], v2 offset:1600
    buffer_load_dwordx4 a[56:59], v240, s[32:35], s87 offen offset:3072 sc1
    v_mfma_f32_16x16x32_bf16 v[28:31], v[76:79], v[104:107], v[28:31]
    ds_read_b128 v[172:175], v3 offset:1664
    v_mfma_f32_16x16x32_bf16 v[32:35], v[76:79], v[108:111], v[32:35]
    v_mfma_f32_16x16x32_bf16 v[24:27], v[64:67], v[112:115], v[24:27]
    ds_read_b64_tr_b16 v[144:145], v2 offset:2120
    v_mfma_f32_16x16x32_bf16 v[28:31], v[68:71], v[112:115], v[28:31]
    ds_read_b64_tr_b16 v[146:147], v2 offset:2112
    buffer_load_dwordx4 a[60:63], v241, s[32:35], s87 offen offset:3072 sc1
    v_mfma_f32_16x16x32_bf16 v[32:35], v[72:75], v[112:115], v[32:35]
    ds_read_b128 v[176:179], v3 offset:2176
    v_mfma_f32_16x16x32_bf16 v[36:39], v[76:79], v[112:115], v[36:39]
    ds_read_b64_tr_b16 v[148:149], v2 offset:2632
    v_mfma_f32_16x16x32_bf16 v[24:27], v[80:83], v[96:99], v[24:27]
    v_mfma_f32_16x16x32_bf16 v[28:31], v[80:83], v[100:103], v[28:31]
    ds_read_b64_tr_b16 v[150:151], v2 offset:2624
    v_mfma_f32_16x16x32_bf16 v[32:35], v[80:83], v[104:107], v[32:35]
    ds_read_b128 v[180:183], v3 offset:2688
    s_add_u32 s87, s83, s84
    s_add_u32 s84, s84, 4096
    s_cmp_eq_u32 s84, 28672
    s_cselect_b32 s84, 0, s84
    buffer_load_dwordx4 a[64:67], v240, s[32:35], s87 offen offset:0 sc1
    v_mfma_f32_16x16x32_bf16 v[36:39], v[80:83], v[108:111], v[36:39]
    ds_read_b64_tr_b16 v[152:153], v2 offset:3144
    s_waitcnt lgkmcnt(15)
    v_mfma_f32_16x16x32_bf16 v[28:31], v[64:67], v[116:119], v[28:31]
    ds_read_b64_tr_b16 v[154:155], v2 offset:3136
    v_mfma_f32_16x16x32_bf16 v[32:35], v[68:71], v[116:119], v[32:35]
    v_mfma_f32_16x16x32_bf16 v[36:39], v[72:75], v[116:119], v[36:39]
    ds_read_b128 v[184:187], v3 offset:3200
    buffer_load_dwordx4 a[68:71], v241, s[32:35], s87 offen offset:0 sc1
    v_mfma_f32_16x16x32_bf16 v[28:31], v[84:87], v[96:99], v[28:31]
    ds_read_b64_tr_b16 v[156:157], v2 offset:3656
    v_mfma_f32_16x16x32_bf16 v[32:35], v[84:87], v[100:103], v[32:35]
    ds_read_b64_tr_b16 v[158:159], v2 offset:3648
    s_cmp_lg_u32 s100, 0
    s_cbranch_scc1 Ltp33
    s_getreg_b32 s90, hwreg(HW_REG_IB_STS)
    s_and_b32 s91, s90, 15
    s_lshr_b32 s90, s90, 18
    s_and_b32 s90, s90, 0x30
    s_or_b32 s90, s90, s91
    s_cmp_gt_u32 s90, 6
    s_cbranch_scc1 Ltp33
    s_lshr_b32 s69, s63, 7
    s_lshl_b32 s69, s69, 6
    s_lshr_b32 s72, s64, 7
    s_lshl_b32 s72, s72, 2
    s_add_u32 s69, s69, s72
    s_add_u32 s69, s69, s3
    s_lshl_b32 s69, s69, 7
    s_add_u32 s69, s69, 14942208
    v_mov_b32 v4, 0
    v_writelane_b32 v4, s69, 0
    v_mov_b32 v5, s16
    s_mov_b64 exec, 1
    buffer_store_dword v5, v4, s[32:35], 0 offen sc1
    s_mov_b64 exec, -1
    s_mov_b32 s100, 1
Ltp33:
    v_mfma_f32_16x16x32_bf16 v[36:39], v[84:87], v[104:107], v[36:39]
    ds_read_b128 v[188:191], v3 offset:3712
    v_mfma_f32_16x16x32_bf16 v[32:35], v[64:67], v[120:123], v[32:35]
    v_mfma_f32_16x16x32_bf16 v[36:39], v[68:71], v[120:123], v[36:39]
    buffer_load_dwordx4 a[72:75], v240, s[32:35], s87 offen offset:1024 sc1
    v_mfma_f32_16x16x32_bf16 v[32:35], v[88:91], v[96:99], v[32:35]
    v_mfma_f32_16x16x32_bf16 v[36:39], v[88:91], v[100:103], v[36:39]
    v_mfma_f32_16x16x32_bf16 v[36:39], v[64:67], v[124:127], v[36:39]
    v_mfma_f32_16x16x32_bf16 v[36:39], v[92:95], v[96:99], v[36:39]
    buffer_load_dwordx4 a[76:79], v241, s[32:35], s87 offen offset:1024 sc1
    v_mfma_f32_16x16x32_bf16 v[8:11], v[128:131], v[160:163], v[8:11]
    s_waitcnt lgkmcnt(15)
    v_mfma_f32_16x16x32_bf16 v[12:15], v[128:131], v[164:167], v[12:15]
    ds_read_b64_tr_b16 v[64:65], v2 offset:136
    v_mfma_f32_16x16x32_bf16 v[12:15], v[132:135], v[160:163], v[12:15]
    ds_read_b64_tr_b16 v[66:67], v2 offset:128
    v_mfma_f32_16x16x32_bf16 v[16:19], v[132:135], v[164:167], v[16:19]
    ds_read_b128 v[96:99], v3 offset:64
    buffer_load_dwordx4 a[80:83], v240, s[32:35], s87 offen offset:2048 sc1
    v_mfma_f32_16x16x32_bf16 v[16:19], v[128:131], v[168:171], v[16:19]
    ds_read_b64_tr_b16 v[68:69], v2 offset:648
    s_cmp_lg_u32 s100, 0
    s_cbranch_scc1 Ltp34
    s_getreg_b32 s90, hwreg(HW_REG_IB_STS)
    s_and_b32 s91, s90, 15
    s_lshr_b32 s90, s90, 18
    s_and_b32 s90, s90, 0x30
    s_or_b32 s90, s90, s91
    s_cmp_gt_u32 s90, 9
    s_cbranch_scc1 Ltp34
    s_lshr_b32 s69, s63, 7
    s_lshl_b32 s69, s69, 6
    s_lshr_b32 s72, s64, 7
    s_lshl_b32 s72, s72, 2
    s_add_u32 s69, s69, s72
    s_add_u32 s69, s69, s3
    s_lshl_b32 s69, s69, 7
    s_add_u32 s69, s69, 14942208
    v_mov_b32 v4, 0
    v_writelane_b32 v4, s69, 0
    v_mov_b32 v5, s16
    s_mov_b64 exec, 1
    buffer_store_dword v5, v4, s[32:35], 0 offen sc1
    s_mov_b64 exec, -1
    s_mov_b32 s100, 1
Ltp34:
    v_mfma_f32_16x16x32_bf16 v[20:23], v[132:135], v[168:171], v[20:23]
    v_mfma_f32_16x16x32_bf16 v[16:19], v[136:139], v[160:163], v[16:19]
    ds_read_b64_tr_b16 v[70:71], v2 offset:640
    v_mfma_f32_16x16x32_bf16 v[20:23], v[136:139], v[164:167], v[20:23]
    ds_read_b128 v[100:103], v3 offset:576
    buffer_load_dwordx4 a[84:87], v241, s[32:35], s87 offen offset:2048 sc1
    v_mfma_f32_16x16x32_bf16 v[24:27], v[136:139], v[168:171], v[24:27]
    ds_read_b64_tr_b16 v[72:73], v2 offset:1160
    s_waitcnt lgkmcnt(15)
    v_mfma_f32_16x16x32_bf16 v[20:23], v[128:131], v[172:175], v[20:23]
    ds_read_b64_tr_b16 v[74:75], v2 offset:1152
    v_mfma_f32_16x16x32_bf16 v[24:27], v[132:135], v[172:175], v[24:27]
    buffer_load_dwordx4 a[88:91], v240, s[32:35], s87 offen offset:3072 sc1
    v_mfma_f32_16x16x32_bf16 v[28:31], v[136:139], v[172:175], v[28:31]
    ds_read_b128 v[104:107], v3 offset:1088
    v_mfma_f32_16x16x32_bf16 v[20:23], v[140:143], v[160:163], v[20:23]
    ds_read_b64_tr_b16 v[76:77], v2 offset:1672
    v_mfma_f32_16x16x32_bf16 v[24:27], v[140:143], v[164:167], v[24:27]
    ds_read_b64_tr_b16 v[78:79], v2 offset:1664
    v_mfma_f32_16x16x32_bf16 v[28:31], v[140:143], v[168:171], v[28:31]
    ds_read_b128 v[108:111], v3 offset:1600
    buffer_load_dwordx4 a[92:95], v241, s[32:35], s87 offen offset:3072 sc1
    v_mfma_f32_16x16x32_bf16 v[32:35], v[140:143], v[172:175], v[32:35]
    v_mfma_f32_16x16x32_bf16 v[24:27], v[128:131], v[176:179], v[24:27]
    ds_read_b64_tr_b16 v[80:81], v2 offset:2184
    v_mfma_f32_16x16x32_bf16 v[28:31], v[132:135], v[176:179], v[28:31]
    ds_read_b64_tr_b16 v[82:83], v2 offset:2176
    s_add_u32 s87, s83, s84
    s_add_u32 s84, s84, 4096
    s_cmp_eq_u32 s84, 28672
    s_cselect_b32 s84, 0, s84
    buffer_load_dwordx4 a[96:99], v240, s[32:35], s87 offen offset:0 sc1
    v_mfma_f32_16x16x32_bf16 v[32:35], v[136:139], v[176:179], v[32:35]
    ds_read_b128 v[112:115], v3 offset:2112
    v_mfma_f32_16x16x32_bf16 v[36:39], v[140:143], v[176:179], v[36:39]
    ds_read_b64_tr_b16 v[84:85], v2 offset:2696
    v_mfma_f32_16x16x32_bf16 v[24:27], v[144:147], v[160:163], v[24:27]
    v_mfma_f32_16x16x32_bf16 v[28:31], v[144:147], v[164:167], v[28:31]
    ds_read_b64_tr_b16 v[86:87], v2 offset:2688
    buffer_load_dwordx4 a[100:103], v241, s[32:35], s87 offen offset:0 sc1
    v_mfma_f32_16x16x32_bf16 v[32:35], v[144:147], v[168:171], v[32:35]
    ds_read_b128 v[116:119], v3 offset:2624
    v_mfma_f32_16x16x32_bf16 v[36:39], v[144:147], v[172:175], v[36:39]
    ds_read_b64_tr_b16 v[88:89], v2 offset:3208
    s_waitcnt lgkmcnt(15)
    v_mfma_f32_16x16x32_bf16 v[28:31], v[128:131], v[180:183], v[28:31]
    ds_read_b64_tr_b16 v[90:91], v2 offset:3200
    s_cmp_lg_u32 s100, 0
    s_cbranch_scc1 Ltp35
    s_getreg_b32 s90, hwreg(HW_REG_IB_STS)
    s_and_b32 s91, s90, 15
    s_lshr_b32 s90, s90, 18
    s_and_b32 s90, s90, 0x30
    s_or_b32 s90, s90, s91
    s_cmp_gt_u32 s90, 14
    s_cbranch_scc1 Ltp35
    s_lshr_b32 s69, s63, 7
    s_lshl_b32 s69, s69, 6
    s_lshr_b32 s72, s64, 7
    s_lshl_b32 s72, s72, 2
    s_add_u32 s69, s69, s72
    s_add_u32 s69, s69, s3
    s_lshl_b32 s69, s69, 7
    s_add_u32 s69, s69, 14942208
    v_mov_b32 v4, 0
    v_writelane_b32 v4, s69, 0
    v_mov_b32 v5, s16
    s_mov_b64 exec, 1
    buffer_store_dword v5, v4, s[32:35], 0 offen sc1
    s_mov_b64 exec, -1
    s_mov_b32 s100, 1
Ltp35:
    v_mfma_f32_16x16x32_bf16 v[32:35], v[132:135], v[180:183], v[32:35]
    buffer_load_dwordx4 a[104:107], v240, s[32:35], s87 offen offset:1024 sc1
    v_mfma_f32_16x16x32_bf16 v[36:39], v[136:139], v[180:183], v[36:39]
    ds_read_b128 v[120:123], v3 offset:3136
    v_mfma_f32_16x16x32_bf16 v[28:31], v[148:151], v[160:163], v[28:31]
    ds_read_b64_tr_b16 v[92:93], v2 offset:3720
    v_mfma_f32_16x16x32_bf16 v[32:35], v[148:151], v[164:167], v[32:35]
    ds_read_b64_tr_b16 v[94:95], v2 offset:3712
    buffer_load_dwordx4 a[108:111], v241, s[32:35], s87 offen offset:1024 sc1
    v_mfma_f32_16x16x32_bf16 v[36:39], v[148:151], v[168:171], v[36:39]
    ds_read_b128 v[124:127], v3 offset:3648
    v_mfma_f32_16x16x32_bf16 v[32:35], v[128:131], v[184:187], v[32:35]
    v_mfma_f32_16x16x32_bf16 v[36:39], v[132:135], v[184:187], v[36:39]
    v_mfma_f32_16x16x32_bf16 v[32:35], v[152:155], v[160:163], v[32:35]
    buffer_load_dwordx4 a[112:115], v240, s[32:35], s87 offen offset:2048 sc1
    v_mfma_f32_16x16x32_bf16 v[36:39], v[152:155], v[164:167], v[36:39]
    v_mfma_f32_16x16x32_bf16 v[36:39], v[128:131], v[188:191], v[36:39]
    v_mfma_f32_16x16x32_bf16 v[36:39], v[156:159], v[160:163], v[36:39]
    buffer_load_dwordx4 a[116:119], v241, s[32:35], s87 offen offset:2048 sc1
    v_mfma_f32_16x16x32_bf16 v[8:11], v[64:67], v[96:99], v[8:11]
    s_waitcnt lgkmcnt(15)
    v_mfma_f32_16x16x32_bf16 v[12:15], v[64:67], v[100:103], v[12:15]
    ds_read_b64_tr_b16 v[128:129], v2 offset:200
    v_mfma_f32_16x16x32_bf16 v[12:15], v[68:71], v[96:99], v[12:15]
    ds_read_b64_tr_b16 v[130:131], v2 offset:192
    v_mfma_f32_16x16x32_bf16 v[16:19], v[68:71], v[100:103], v[16:19]
    ds_read_b128 v[160:163], v3 offset:0
    s_waitcnt vmcnt(60)
    buffer_load_dwordx4 a[120:123], v240, s[32:35], s87 offen offset:3072 sc1
    v_mfma_f32_16x16x32_bf16 v[16:19], v[64:67], v[104:107], v[16:19]
    ds_read_b64_tr_b16 v[132:133], v2 offset:712
    v_mfma_f32_16x16x32_bf16 v[20:23], v[68:71], v[104:107], v[20:23]
    v_mfma_f32_16x16x32_bf16 v[16:19], v[72:75], v[96:99], v[16:19]
    ds_read_b64_tr_b16 v[134:135], v2 offset:704
    v_mfma_f32_16x16x32_bf16 v[20:23], v[72:75], v[100:103], v[20:23]
    ds_read_b128 v[164:167], v3 offset:512
    buffer_load_dwordx4 a[124:127], v241, s[32:35], s87 offen offset:3072 sc1
    v_mfma_f32_16x16x32_bf16 v[24:27], v[72:75], v[104:107], v[24:27]
    ds_read_b64_tr_b16 v[136:137], v2 offset:1224
    s_waitcnt lgkmcnt(15)
    v_mfma_f32_16x16x32_bf16 v[20:23], v[64:67], v[108:111], v[20:23]
    ds_read_b64_tr_b16 v[138:139], v2 offset:1216
    v_mfma_f32_16x16x32_bf16 v[24:27], v[68:71], v[108:111], v[24:27]
    s_add_u32 s87, s83, s84
    s_add_u32 s84, s84, 4096
    s_cmp_eq_u32 s84, 28672
    s_cselect_b32 s84, 0, s84
    s_waitcnt vmcnt(60)
    buffer_load_dwordx4 a[128:131], v240, s[32:35], s87 offen offset:0 sc1
    v_mfma_f32_16x16x32_bf16 v[28:31], v[72:75], v[108:111], v[28:31]
    ds_read_b128 v[168:171], v3 offset:1024
    v_mfma_f32_16x16x32_bf16 v[20:23], v[76:79], v[96:99], v[20:23]
    ds_read_b64_tr_b16 v[140:141], v2 offset:1736
    v_mfma_f32_16x16x32_bf16 v[24:27], v[76:79], v[100:103], v[24:27]
    ds_read_b64_tr_b16 v[142:143], v2 offset:1728
    v_mfma_f32_16x16x32_bf16 v[28:31], v[76:79], v[104:107], v[28:31]
    ds_read_b128 v[172:175], v3 offset:1536
    buffer_load_dwordx4 a[132:135], v241, s[32:35], s87 offen offset:0 sc1
    v_mfma_f32_16x16x32_bf16 v[32:35], v[76:79], v[108:111], v[32:35]
    v_mfma_f32_16x16x32_bf16 v[24:27], v[64:67], v[112:115], v[24:27]
    ds_read_b64_tr_b16 v[144:145], v2 offset:2248
    v_mfma_f32_16x16x32_bf16 v[28:31], v[68:71], v[112:115], v[28:31]
    ds_read_b64_tr_b16 v[146:147], v2 offset:2240
    s_waitcnt vmcnt(60)
    buffer_load_dwordx4 a[136:139], v240, s[32:35], s87 offen offset:1024 sc1
    v_mfma_f32_16x16x32_bf16 v[32:35], v[72:75], v[112:115], v[32:35]
    ds_read_b128 v[176:179], v3 offset:2048
    v_mfma_f32_16x16x32_bf16 v[36:39], v[76:79], v[112:115], v[36:39]
    ds_read_b64_tr_b16 v[148:149], v2 offset:2760
    v_mfma_f32_16x16x32_bf16 v[24:27], v[80:83], v[96:99], v[24:27]
    s_cmp_lg_u32 s100, 0
    s_cbranch_scc1 Ltp36
    s_getreg_b32 s90, hwreg(HW_REG_IB_STS)
    s_and_b32 s91, s90, 15
    s_lshr_b32 s90, s90, 18
    s_and_b32 s90, s90, 0x30
    s_or_b32 s90, s90, s91
    s_cmp_gt_u32 s90, 23
    s_cbranch_scc1 Ltp36
    s_lshr_b32 s69, s63, 7
    s_lshl_b32 s69, s69, 6
    s_lshr_b32 s72, s64, 7
    s_lshl_b32 s72, s72, 2
    s_add_u32 s69, s69, s72
    s_add_u32 s69, s69, s3
    s_lshl_b32 s69, s69, 7
    s_add_u32 s69, s69, 14942208
    v_mov_b32 v4, 0
    v_writelane_b32 v4, s69, 0
    v_mov_b32 v5, s16
    s_mov_b64 exec, 1
    buffer_store_dword v5, v4, s[32:35], 0 offen sc1
    s_mov_b64 exec, -1
    s_mov_b32 s100, 1
Ltp36:
    v_mfma_f32_16x16x32_bf16 v[28:31], v[80:83], v[100:103], v[28:31]
    ds_read_b64_tr_b16 v[150:151], v2 offset:2752
    s_waitcnt vmcnt(60)
    buffer_load_dwordx4 a[140:143], v241, s[32:35], s87 offen offset:1024 sc1
    v_mfma_f32_16x16x32_bf16 v[32:35], v[80:83], v[104:107], v[32:35]
    ds_read_b128 v[180:183], v3 offset:2560
    v_mfma_f32_16x16x32_bf16 v[36:39], v[80:83], v[108:111], v[36:39]
    ds_read_b64_tr_b16 v[152:153], v2 offset:3272
    s_waitcnt lgkmcnt(15)
    v_mfma_f32_16x16x32_bf16 v[28:31], v[64:67], v[116:119], v[28:31]
    ds_read_b64_tr_b16 v[154:155], v2 offset:3264
    v_mfma_f32_16x16x32_bf16 v[32:35], v[68:71], v[116:119], v[32:35]
    buffer_load_dwordx4 a[144:147], v240, s[32:35], s87 offen offset:2048 sc1
    v_mfma_f32_16x16x32_bf16 v[36:39], v[72:75], v[116:119], v[36:39]
    ds_read_b128 v[184:187], v3 offset:3072
    v_mfma_f32_16x16x32_bf16 v[28:31], v[84:87], v[96:99], v[28:31]
    ds_read_b64_tr_b16 v[156:157], v2 offset:3784
    v_mfma_f32_16x16x32_bf16 v[32:35], v[84:87], v[100:103], v[32:35]
    ds_read_b64_tr_b16 v[158:159], v2 offset:3776
    s_waitcnt vmcnt(60)
    buffer_load_dwordx4 a[148:151], v241, s[32:35], s87 offen offset:2048 sc1
    v_mfma_f32_16x16x32_bf16 v[36:39], v[84:87], v[104:107], v[36:39]
    ds_read_b128 v[188:191], v3 offset:3584
    v_mfma_f32_16x16x32_bf16 v[32:35], v[64:67], v[120:123], v[32:35]
    v_mfma_f32_16x16x32_bf16 v[36:39], v[68:71], v[120:123], v[36:39]
    v_mfma_f32_16x16x32_bf16 v[32:35], v[88:91], v[96:99], v[32:35]
    buffer_load_dwordx4 a[152:155], v240, s[32:35], s87 offen offset:3072 sc1
    v_mfma_f32_16x16x32_bf16 v[36:39], v[88:91], v[100:103], v[36:39]
    v_mfma_f32_16x16x32_bf16 v[36:39], v[64:67], v[124:127], v[36:39]
    v_mfma_f32_16x16x32_bf16 v[36:39], v[92:95], v[96:99], v[36:39]
    s_waitcnt vmcnt(60)
    buffer_load_dwordx4 a[156:159], v241, s[32:35], s87 offen offset:3072 sc1
    v_mfma_f32_16x16x32_bf16 v[8:11], v[128:131], v[160:163], v[8:11]
    s_waitcnt lgkmcnt(15)
    v_mfma_f32_16x16x32_bf16 v[12:15], v[128:131], v[164:167], v[12:15]
    v_mfma_f32_16x16x32_bf16 v[12:15], v[132:135], v[160:163], v[12:15]
    v_mfma_f32_16x16x32_bf16 v[16:19], v[132:135], v[164:167], v[16:19]
    s_add_u32 s87, s83, s84
    s_add_u32 s84, s84, 4096
    s_cmp_eq_u32 s84, 28672
    s_cselect_b32 s84, 0, s84
    buffer_load_dwordx4 a[160:163], v240, s[32:35], s87 offen offset:0 sc1
    v_mfma_f32_16x16x32_bf16 v[16:19], v[128:131], v[168:171], v[16:19]
    v_mfma_f32_16x16x32_bf16 v[20:23], v[132:135], v[168:171], v[20:23]
    v_mfma_f32_16x16x32_bf16 v[16:19], v[136:139], v[160:163], v[16:19]
    v_mfma_f32_16x16x32_bf16 v[20:23], v[136:139], v[164:167], v[20:23]
    s_waitcnt vmcnt(60)
    buffer_load_dwordx4 a[164:167], v241, s[32:35], s87 offen offset:0 sc1
    v_mfma_f32_16x16x32_bf16 v[24:27], v[136:139], v[168:171], v[24:27]
    s_waitcnt lgkmcnt(12)
    v_mfma_f32_16x16x32_bf16 v[20:23], v[128:131], v[172:175], v[20:23]
    v_mfma_f32_16x16x32_bf16 v[24:27], v[132:135], v[172:175], v[24:27]
    buffer_load_dwordx4 a[168:171], v240, s[32:35], s87 offen offset:1024 sc1
    v_mfma_f32_16x16x32_bf16 v[28:31], v[136:139], v[172:175], v[28:31]
    v_mfma_f32_16x16x32_bf16 v[20:23], v[140:143], v[160:163], v[20:23]
    v_mfma_f32_16x16x32_bf16 v[24:27], v[140:143], v[164:167], v[24:27]
    v_mfma_f32_16x16x32_bf16 v[28:31], v[140:143], v[168:171], v[28:31]
    s_waitcnt vmcnt(60)
    buffer_load_dwordx4 a[172:175], v241, s[32:35], s87 offen offset:1024 sc1
    s_cmp_lg_u32 s3, 0
    s_cbranch_scc1 Lw037
    s_lshr_b32 s45, s81, 7
    s_lshl_b32 s45, s45, 13
    s_add_u32 s45, s45, 14942208
    s_bfe_u32 s89, s81, 0x10006
    s_lshl_b32 s89, s89, 8
    s_add_u32 s45, s45, s89
    v_lshrrev_b32 v216, 1, v1
    v_min_u32 v216, 13, v216
    v_lshlrev_b32 v216, 2, v216
    v_and_b32 v217, 1, v1
    v_add_u32 v216, v216, v217
    v_lshl_add_u32 v216, v216, 7, s45
    buffer_load_dword v217, v216, s[32:35], 0 offen sc1
Lw037:
    v_mfma_f32_16x16x32_bf16 v[32:35], v[140:143], v[172:175], v[32:35]
    s_waitcnt lgkmcnt(9)
    v_mfma_f32_16x16x32_bf16 v[24:27], v[128:131], v[176:179], v[24:27]
    v_mfma_f32_16x16x32_bf16 v[28:31], v[132:135], v[176:179], v[28:31]
    s_waitcnt vmcnt(60)
    buffer_load_dwordx4 a[176:179], v240, s[32:35], s87 offen offset:2048 sc1
    v_mfma_f32_16x16x32_bf16 v[32:35], v[136:139], v[176:179], v[32:35]
    v_mfma_f32_16x16x32_bf16 v[36:39], v[140:143], v[176:179], v[36:39]
    v_mfma_f32_16x16x32_bf16 v[24:27], v[144:147], v[160:163], v[24:27]
    v_mfma_f32_16x16x32_bf16 v[28:31], v[144:147], v[164:167], v[28:31]
    buffer_load_dwordx4 a[180:183], v241, s[32:35], s87 offen offset:2048 sc1
    v_mfma_f32_16x16x32_bf16 v[32:35], v[144:147], v[168:171], v[32:35]
    v_mfma_f32_16x16x32_bf16 v[36:39], v[144:147], v[172:175], v[36:39]
    s_waitcnt lgkmcnt(6)
    v_mfma_f32_16x16x32_bf16 v[28:31], v[128:131], v[180:183], v[28:31]
    v_mfma_f32_16x16x32_bf16 v[32:35], v[132:135], v[180:183], v[32:35]
    s_waitcnt vmcnt(60)
    buffer_load_dwordx4 a[184:187], v240, s[32:35], s87 offen offset:3072 sc1
    v_mfma_f32_16x16x32_bf16 v[36:39], v[136:139], v[180:183], v[36:39]
    v_mfma_f32_16x16x32_bf16 v[28:31], v[148:151], v[160:163], v[28:31]
    v_mfma_f32_16x16x32_bf16 v[32:35], v[148:151], v[164:167], v[32:35]
    buffer_load_dwordx4 a[188:191], v241, s[32:35], s87 offen offset:3072 sc1
    v_mfma_f32_16x16x32_bf16 v[36:39], v[148:151], v[168:171], v[36:39]
    s_waitcnt lgkmcnt(3)
    v_mfma_f32_16x16x32_bf16 v[32:35], v[128:131], v[184:187], v[32:35]
    v_mfma_f32_16x16x32_bf16 v[36:39], v[132:135], v[184:187], v[36:39]
    v_mfma_f32_16x16x32_bf16 v[32:35], v[152:155], v[160:163], v[32:35]
    s_add_u32 s87, s83, s84
    s_add_u32 s84, s84, 4096
    s_cmp_eq_u32 s84, 28672
    s_cselect_b32 s84, 0, s84
    s_waitcnt vmcnt(60)
    buffer_load_dwordx4 a[192:195], v240, s[32:35], s87 offen offset:0 sc1
    v_mfma_f32_16x16x32_bf16 v[36:39], v[152:155], v[164:167], v[36:39]
    s_waitcnt lgkmcnt(0)
    v_mfma_f32_16x16x32_bf16 v[36:39], v[128:131], v[188:191], v[36:39]
    v_mfma_f32_16x16x32_bf16 v[36:39], v[156:159], v[160:163], v[36:39]
    buffer_load_dwordx4 a[196:199], v241, s[32:35], s87 offen offset:0 sc1
    s_cmp_lg_u32 s100, 0
    s_cbranch_scc1 Ltp38
    s_waitcnt vmcnt(38)
    s_lshr_b32 s69, s63, 7
    s_lshl_b32 s69, s69, 6
    s_lshr_b32 s72, s64, 7
    s_lshl_b32 s72, s72, 2
    s_add_u32 s69, s69, s72
    s_add_u32 s69, s69, s3
    s_lshl_b32 s69, s69, 7
    s_add_u32 s69, s69, 14942208
    v_mov_b32 v4, 0
    v_writelane_b32 v4, s69, 0
    v_mov_b32 v5, s16
    s_mov_b64 exec, 1
    s_waitcnt vmcnt(60)
    buffer_store_dword v5, v4, s[32:35], 0 offen sc1
    s_mov_b64 exec, -1
    s_mov_b32 s100, 1
Ltp38:
    v_lshlrev_b32 v218, 4, v1
    v_add_u32 v219, 114688, v218
    v_lshlrev_b32 v4, 4, v1
    s_lshl_b32 s78, s3, 12
    s_add_u32 s78, s78, 9216
    v_add_u32 v5, s78, v4
    s_xor_b32 s79, s3, 1
    s_lshl_b32 s79, s79, 12
    s_add_u32 s79, s79, 9216
    v_add_u32 v6, s79, v4
    s_cmp_eq_u32 s77, 0
    s_cbranch_scc0 Lce39
    ds_write_b128 v5, v[24:27] offset:0
    ds_write_b128 v5, v[28:31] offset:1024
    ds_write_b128 v5, v[32:35] offset:2048
    ds_write_b128 v5, v[36:39] offset:3072
    v_mov_b64 v[40:41], v[8:9]
    v_mov_b64 v[42:43], v[10:11]
    v_mov_b64 v[44:45], v[12:13]
    v_mov_b64 v[46:47], v[14:15]
    v_mov_b64 v[48:49], v[16:17]
    v_mov_b64 v[50:51], v[18:19]
    v_mov_b64 v[52:53], v[20:21]
    v_mov_b64 v[54:55], v[22:23]
    s_branch Lce40
Lce39:
    s_nop 7
    ds_write_b128 v5, v[8:11] offset:0
    ds_write_b128 v5, v[12:15] offset:1024
    ds_write_b128 v5, v[16:19] offset:2048
    ds_write_b128 v5, v[20:23] offset:3072
    v_mov_b64 v[40:41], v[24:25]
    v_mov_b64 v[42:43], v[26:27]
    v_mov_b64 v[44:45], v[28:29]
    v_mov_b64 v[46:47], v[30:31]
    v_mov_b64 v[48:49], v[32:33]
    v_mov_b64 v[50:51], v[34:35]
    v_mov_b64 v[52:53], v[36:37]
    v_mov_b64 v[54:55], v[38:39]
Lce40:
    s_waitcnt lgkmcnt(0)
    s_barrier
    ds_read_b128 v[184:187], v6 offset:0
    ds_read_b128 v[188:191], v6 offset:1024
    ds_read_b128 v[192:195], v6 offset:2048
    ds_read_b128 v[196:199], v6 offset:3072
    v_and_b32 v4, 15, v1
    v_lshlrev_b32 v4, 5, v4
    v_lshrrev_b32 v5, 4, v1
    v_lshl_add_u32 v4, v5, 3, v4
    s_mul_i32 s78, s76, 4608
    s_lshl_b32 s79, s77, 11
    s_add_u32 s78, s78, s79
    s_add_u32 s78, s78, 512
    v_add_u32 v5, s78, v4
    ds_read_b64 v[200:201], v5 offset:0
    ds_read_b64 v[202:203], v5 offset:512
    ds_read_b64 v[204:205], v5 offset:1024
    ds_read_b64 v[206:207], v5 offset:1536
    s_lshl_b32 s78, s75, 16
    s_and_b32 s79, s75, 0xffff0000
    s_cmp_eq_u32 s76, 0
    s_cselect_b32 s78, s78, s79
    s_lshl_b32 s79, s2, 1
    s_add_u32 s79, s79, s76
    s_lshl_b32 s79, s79, 12
    s_lshl_b32 s80, s77, 11
    s_add_u32 s79, s79, s80
    s_add_u32 s79, s79, 2097152
    buffer_load_dwordx4 a[200:203], v240, s[32:35], s87 offen offset:1024 sc1
    s_waitcnt vmcnt(60)
    buffer_load_dwordx4 a[204:207], v241, s[32:35], s87 offen offset:1024 sc1
    s_waitcnt lgkmcnt(4)
    v_pk_add_f32 v[40:41], v[40:41], v[184:185]
    v_pk_add_f32 v[42:43], v[42:43], v[186:187]
    v_pk_add_f32 v[44:45], v[44:45], v[188:189]
    v_pk_add_f32 v[46:47], v[46:47], v[190:191]
    v_pk_add_f32 v[48:49], v[48:49], v[192:193]
    v_pk_add_f32 v[50:51], v[50:51], v[194:195]
    v_pk_add_f32 v[52:53], v[52:53], v[196:197]
    v_pk_add_f32 v[54:55], v[54:55], v[198:199]
    buffer_load_dwordx4 a[208:211], v240, s[32:35], s87 offen offset:2048 sc1
    s_waitcnt lgkmcnt(0)
    v_lshlrev_b32 v208, 16, v200
    v_and_b32 v209, 0xffff0000, v200
    v_lshlrev_b32 v210, 16, v201
    v_and_b32 v211, 0xffff0000, v201
    v_fmac_f32 v40, s78, v208
    v_fmac_f32 v41, s78, v209
    v_fmac_f32 v42, s78, v210
    v_fmac_f32 v43, s78, v211
    s_waitcnt vmcnt(60)
    buffer_load_dwordx4 a[212:215], v241, s[32:35], s87 offen offset:2048 sc1
    v_cvt_pk_bf16_f32 v220, v40, v41
    v_cvt_pk_bf16_f32 v221, v42, v43
    buffer_store_dwordx2 v[220:221], v4, s[32:35], s79 offen offset:0 sc1
    v_lshlrev_b32 v208, 16, v202
    v_and_b32 v209, 0xffff0000, v202
    v_lshlrev_b32 v210, 16, v203
    v_and_b32 v211, 0xffff0000, v203
    v_fmac_f32 v44, s78, v208
    v_fmac_f32 v45, s78, v209
    v_fmac_f32 v46, s78, v210
    v_fmac_f32 v47, s78, v211
    s_waitcnt vmcnt(60)
    buffer_load_dwordx4 a[216:219], v240, s[32:35], s87 offen offset:3072 sc1
    v_cvt_pk_bf16_f32 v222, v44, v45
    v_cvt_pk_bf16_f32 v223, v46, v47
    buffer_store_dwordx2 v[222:223], v4, s[32:35], s79 offen offset:512 sc1
    v_lshlrev_b32 v208, 16, v204
    v_and_b32 v209, 0xffff0000, v204
    v_lshlrev_b32 v210, 16, v205
    v_and_b32 v211, 0xffff0000, v205
    v_fmac_f32 v48, s78, v208
    v_fmac_f32 v49, s78, v209
    v_fmac_f32 v50, s78, v210
    v_fmac_f32 v51, s78, v211
    v_cvt_pk_bf16_f32 v224, v48, v49
    v_cvt_pk_bf16_f32 v225, v50, v51
    s_waitcnt vmcnt(60)
    buffer_store_dwordx2 v[224:225], v4, s[32:35], s79 offen offset:1024 sc1
    v_lshlrev_b32 v208, 16, v206
    v_and_b32 v209, 0xffff0000, v206
    v_lshlrev_b32 v210, 16, v207
    v_and_b32 v211, 0xffff0000, v207
    v_fmac_f32 v52, s78, v208
    v_fmac_f32 v53, s78, v209
    v_fmac_f32 v54, s78, v210
    v_fmac_f32 v55, s78, v211
    buffer_load_dwordx4 a[220:223], v241, s[32:35], s87 offen offset:3072 sc1
    v_cvt_pk_bf16_f32 v226, v52, v53
    v_cvt_pk_bf16_f32 v227, v54, v55
    s_waitcnt vmcnt(60)
    buffer_store_dwordx2 v[226:227], v4, s[32:35], s79 offen offset:1536 sc1
    v_mov_b64 v[8:9], 0
    v_mov_b64 v[10:11], 0
    v_mov_b64 v[12:13], 0
    v_mov_b64 v[14:15], 0
    v_mov_b64 v[16:17], 0
    v_mov_b64 v[18:19], 0
    v_mov_b64 v[20:21], 0
    v_mov_b64 v[22:23], 0
    v_mov_b64 v[24:25], 0
    v_mov_b64 v[26:27], 0
    v_mov_b64 v[28:29], 0
    v_mov_b64 v[30:31], 0
    v_mov_b64 v[32:33], 0
    v_mov_b64 v[34:35], 0
    v_mov_b64 v[36:37], 0
    v_mov_b64 v[38:39], 0
    v_mov_b64 v[40:41], 0
    v_mov_b64 v[42:43], 0
    v_mov_b64 v[44:45], 0
    v_mov_b64 v[46:47], 0
    v_mov_b64 v[48:49], 0
    v_mov_b64 v[50:51], 0
    v_mov_b64 v[52:53], 0
    v_mov_b64 v[54:55], 0
    v_mov_b64 v[56:57], 0
    v_mov_b64 v[58:59], 0
    v_mov_b64 v[60:61], 0
    v_mov_b64 v[62:63], 0
    v_mov_b64 v[64:65], 0
    v_mov_b64 v[66:67], 0
    v_mov_b64 v[68:69], 0
    v_mov_b64 v[70:71], 0
    s_cmp_lg_u32 s3, 0
    s_cbranch_scc1 Lw041
    s_waitcnt vmcnt(16)
    s_mov_b32 s17, 0
Lpc42:
    v_cmp_ne_u32 vcc, s16, v217
    s_nop 1
    s_mov_b64 s[90:91], vcc
    s_cmp_eq_u64 s[90:91], 0
    s_cbranch_scc1 Lpd43
    s_add_u32 s17, s17, 1
    s_cmp_gt_u32 s17, 100000
    s_cbranch_scc1 Lpd43
    s_sleep 2
    buffer_load_dword v217, v216, s[32:35], 0 offen sc1
    s_waitcnt vmcnt(0)
    s_branch Lpc42
Lpd43:
Lw041:
    s_barrier
    s_add_u32 s88, s85, s86
    s_add_u32 s86, s86, 4096
    s_cmp_eq_u32 s86, 28672
    s_cselect_b32 s86, 0, s86
    s_waitcnt vmcnt(60)
    buffer_load_dwordx4 v[72:75], v218, s[32:35], s88 offen offset:0 sc1
    buffer_load_dwordx4 v[76:79], v219, s[32:35], s88 offen offset:0 sc1
    s_waitcnt vmcnt(60)
    buffer_load_dwordx4 v[80:83], v218, s[32:35], s88 offen offset:1024 sc1
    buffer_load_dwordx4 v[84:87], v219, s[32:35], s88 offen offset:1024 sc1
    s_waitcnt vmcnt(60)
    buffer_load_dwordx4 v[88:91], v218, s[32:35], s88 offen offset:2048 sc1
    buffer_load_dwordx4 v[92:95], v219, s[32:35], s88 offen offset:2048 sc1
    s_waitcnt vmcnt(60)
    buffer_load_dwordx4 v[96:99], v218, s[32:35], s88 offen offset:3072 sc1
    buffer_load_dwordx4 v[100:103], v219, s[32:35], s88 offen offset:3072 sc1
    s_add_u32 s88, s85, s86
    s_add_u32 s86, s86, 4096
    s_cmp_eq_u32 s86, 28672
    s_cselect_b32 s86, 0, s86
    s_waitcnt vmcnt(60)
    buffer_load_dwordx4 v[104:107], v218, s[32:35], s88 offen offset:0 sc1
    buffer_load_dwordx4 v[108:111], v219, s[32:35], s88 offen offset:0 sc1
    s_waitcnt vmcnt(60)
    buffer_load_dwordx4 v[112:115], v218, s[32:35], s88 offen offset:1024 sc1
    buffer_load_dwordx4 v[116:119], v219, s[32:35], s88 offen offset:1024 sc1
    s_waitcnt vmcnt(60)
    buffer_load_dwordx4 v[120:123], v218, s[32:35], s88 offen offset:2048 sc1
    buffer_load_dwordx4 v[124:127], v219, s[32:35], s88 offen offset:2048 sc1
    s_waitcnt vmcnt(60)
    buffer_load_dwordx4 v[128:131], v218, s[32:35], s88 offen offset:3072 sc1
    buffer_load_dwordx4 v[132:135], v219, s[32:35], s88 offen offset:3072 sc1
    s_add_u32 s88, s85, s86
    s_add_u32 s86, s86, 4096
    s_cmp_eq_u32 s86, 28672
    s_cselect_b32 s86, 0, s86
    s_waitcnt vmcnt(60)
    buffer_load_dwordx4 v[136:139], v218, s[32:35], s88 offen offset:0 sc1
    buffer_load_dwordx4 v[140:143], v219, s[32:35], s88 offen offset:0 sc1
    s_waitcnt vmcnt(60)
    buffer_load_dwordx4 v[144:147], v218, s[32:35], s88 offen offset:1024 sc1
    buffer_load_dwordx4 v[148:151], v219, s[32:35], s88 offen offset:1024 sc1
    s_waitcnt vmcnt(60)
    buffer_load_dwordx4 v[152:155], v218, s[32:35], s88 offen offset:2048 sc1
    buffer_load_dwordx4 v[156:159], v219, s[32:35], s88 offen offset:2048 sc1
    s_waitcnt vmcnt(60)
    buffer_load_dwordx4 v[160:163], v218, s[32:35], s88 offen offset:3072 sc1
    buffer_load_dwordx4 v[164:167], v219, s[32:35], s88 offen offset:3072 sc1
    s_add_u32 s88, s85, s86
    s_add_u32 s86, s86, 4096
    s_cmp_eq_u32 s86, 28672
    s_cselect_b32 s86, 0, s86
    s_waitcnt vmcnt(60)
    buffer_load_dwordx4 v[168:171], v218, s[32:35], s88 offen offset:0 sc1
    buffer_load_dwordx4 v[172:175], v219, s[32:35], s88 offen offset:0 sc1
    s_waitcnt vmcnt(60)
    buffer_load_dwordx4 v[176:179], v218, s[32:35], s88 offen offset:1024 sc1
    buffer_load_dwordx4 v[180:183], v219, s[32:35], s88 offen offset:1024 sc1
    s_waitcnt vmcnt(28)
    s_lshr_b32 s78, s2, 5
    s_lshl_b32 s78, s78, 1
    s_add_u32 s78, s78, s77
    s_lshl_b32 s78, s78, 6
    s_and_b32 s45, s2, 31
    s_lshl_b32 s45, s45, 1
    s_add_u32 s78, s78, s45
    s_add_u32 s78, s78, s76
    s_lshl_b32 s78, s78, 7
    s_add_u32 s78, s78, 15073280
    v_mov_b32 v6, 0
    v_writelane_b32 v6, s78, 0
    v_mov_b32 v7, s16
    s_mov_b64 exec, 1
    buffer_store_dword v7, v6, s[32:35], 0 offen sc1
    s_mov_b64 exec, -1
    s_waitcnt vmcnt(27)
    v_mfma_f32_32x32x16_bf16 v[8:23], a[0:3], v[72:75], v[8:23]
    v_mfma_f32_32x32x16_bf16 v[24:39], a[0:3], v[76:79], v[24:39]
    v_mfma_f32_32x32x16_bf16 v[40:55], a[4:7], v[72:75], v[40:55]
    buffer_load_dwordx4 v[72:75], v218, s[32:35], s88 offen offset:2048 sc1
    v_mfma_f32_32x32x16_bf16 v[56:71], a[4:7], v[76:79], v[56:71]
    buffer_load_dwordx4 v[76:79], v219, s[32:35], s88 offen offset:2048 sc1
    s_waitcnt vmcnt(27)
    v_mfma_f32_32x32x16_bf16 v[8:23], a[8:11], v[80:83], v[8:23]
    v_mfma_f32_32x32x16_bf16 v[24:39], a[8:11], v[84:87], v[24:39]
    v_mfma_f32_32x32x16_bf16 v[40:55], a[12:15], v[80:83], v[40:55]
    buffer_load_dwordx4 v[80:83], v218, s[32:35], s88 offen offset:3072 sc1
    v_mfma_f32_32x32x16_bf16 v[56:71], a[12:15], v[84:87], v[56:71]
    buffer_load_dwordx4 v[84:87], v219, s[32:35], s88 offen offset:3072 sc1
    s_waitcnt vmcnt(27)
    v_mfma_f32_32x32x16_bf16 v[8:23], a[16:19], v[88:91], v[8:23]
    v_mfma_f32_32x32x16_bf16 v[24:39], a[16:19], v[92:95], v[24:39]
    v_mfma_f32_32x32x16_bf16 v[40:55], a[20:23], v[88:91], v[40:55]
    s_add_u32 s88, s85, s86
    s_add_u32 s86, s86, 4096
    s_cmp_eq_u32 s86, 28672
    s_cselect_b32 s86, 0, s86
    buffer_load_dwordx4 v[88:91], v218, s[32:35], s88 offen offset:0 sc1
    v_mfma_f32_32x32x16_bf16 v[56:71], a[20:23], v[92:95], v[56:71]
    buffer_load_dwordx4 v[92:95], v219, s[32:35], s88 offen offset:0 sc1
    s_waitcnt vmcnt(27)
    v_mfma_f32_32x32x16_bf16 v[8:23], a[24:27], v[96:99], v[8:23]
    v_mfma_f32_32x32x16_bf16 v[24:39], a[24:27], v[100:103], v[24:39]
    v_mfma_f32_32x32x16_bf16 v[40:55], a[28:31], v[96:99], v[40:55]
    buffer_load_dwordx4 v[96:99], v218, s[32:35], s88 offen offset:1024 sc1
    v_mfma_f32_32x32x16_bf16 v[56:71], a[28:31], v[100:103], v[56:71]
    buffer_load_dwordx4 v[100:103], v219, s[32:35], s88 offen offset:1024 sc1
    s_waitcnt vmcnt(27)
    v_mfma_f32_32x32x16_bf16 v[8:23], a[32:35], v[104:107], v[8:23]
    v_mfma_f32_32x32x16_bf16 v[24:39], a[32:35], v[108:111], v[24:39]
    v_mfma_f32_32x32x16_bf16 v[40:55], a[36:39], v[104:107], v[40:55]
    buffer_load_dwordx4 v[104:107], v218, s[32:35], s88 offen offset:2048 sc1
    v_mfma_f32_32x32x16_bf16 v[56:71], a[36:39], v[108:111], v[56:71]
    buffer_load_dwordx4 v[108:111], v219, s[32:35], s88 offen offset:2048 sc1
    s_waitcnt vmcnt(27)
    v_mfma_f32_32x32x16_bf16 v[8:23], a[40:43], v[112:115], v[8:23]
    v_mfma_f32_32x32x16_bf16 v[24:39], a[40:43], v[116:119], v[24:39]
    v_mfma_f32_32x32x16_bf16 v[40:55], a[44:47], v[112:115], v[40:55]
    buffer_load_dwordx4 v[112:115], v218, s[32:35], s88 offen offset:3072 sc1
    v_mfma_f32_32x32x16_bf16 v[56:71], a[44:47], v[116:119], v[56:71]
    buffer_load_dwordx4 v[116:119], v219, s[32:35], s88 offen offset:3072 sc1
    s_waitcnt vmcnt(27)
    v_mfma_f32_32x32x16_bf16 v[8:23], a[48:51], v[120:123], v[8:23]
    v_mfma_f32_32x32x16_bf16 v[24:39], a[48:51], v[124:127], v[24:39]
    v_mfma_f32_32x32x16_bf16 v[40:55], a[52:55], v[120:123], v[40:55]
    s_add_u32 s88, s85, s86
    s_add_u32 s86, s86, 4096
    s_cmp_eq_u32 s86, 28672
    s_cselect_b32 s86, 0, s86
    buffer_load_dwordx4 v[120:123], v218, s[32:35], s88 offen offset:0 sc1
    v_mfma_f32_32x32x16_bf16 v[56:71], a[52:55], v[124:127], v[56:71]
    buffer_load_dwordx4 v[124:127], v219, s[32:35], s88 offen offset:0 sc1
    s_waitcnt vmcnt(27)
    v_mfma_f32_32x32x16_bf16 v[8:23], a[56:59], v[128:131], v[8:23]
    v_mfma_f32_32x32x16_bf16 v[24:39], a[56:59], v[132:135], v[24:39]
    v_mfma_f32_32x32x16_bf16 v[40:55], a[60:63], v[128:131], v[40:55]
    buffer_load_dwordx4 v[128:131], v218, s[32:35], s88 offen offset:1024 sc1
    v_mfma_f32_32x32x16_bf16 v[56:71], a[60:63], v[132:135], v[56:71]
    buffer_load_dwordx4 v[132:135], v219, s[32:35], s88 offen offset:1024 sc1
    s_waitcnt vmcnt(27)
    v_mfma_f32_32x32x16_bf16 v[8:23], a[64:67], v[136:139], v[8:23]
    v_mfma_f32_32x32x16_bf16 v[24:39], a[64:67], v[140:143], v[24:39]
    v_mfma_f32_32x32x16_bf16 v[40:55], a[68:71], v[136:139], v[40:55]
    buffer_load_dwordx4 v[136:139], v218, s[32:35], s88 offen offset:2048 sc1
    v_mfma_f32_32x32x16_bf16 v[56:71], a[68:71], v[140:143], v[56:71]
    buffer_load_dwordx4 v[140:143], v219, s[32:35], s88 offen offset:2048 sc1
    s_waitcnt vmcnt(27)
    v_mfma_f32_32x32x16_bf16 v[8:23], a[72:75], v[144:147], v[8:23]
    v_mfma_f32_32x32x16_bf16 v[24:39], a[72:75], v[148:151], v[24:39]
    v_mfma_f32_32x32x16_bf16 v[40:55], a[76:79], v[144:147], v[40:55]
    buffer_load_dwordx4 v[144:147], v218, s[32:35], s88 offen offset:3072 sc1
    v_mfma_f32_32x32x16_bf16 v[56:71], a[76:79], v[148:151], v[56:71]
    buffer_load_dwordx4 v[148:151], v219, s[32:35], s88 offen offset:3072 sc1
    s_waitcnt vmcnt(27)
    v_mfma_f32_32x32x16_bf16 v[8:23], a[80:83], v[152:155], v[8:23]
    v_mfma_f32_32x32x16_bf16 v[24:39], a[80:83], v[156:159], v[24:39]
    v_mfma_f32_32x32x16_bf16 v[40:55], a[84:87], v[152:155], v[40:55]
    s_add_u32 s88, s85, s86
    s_add_u32 s86, s86, 4096
    s_cmp_eq_u32 s86, 28672
    s_cselect_b32 s86, 0, s86
    buffer_load_dwordx4 v[152:155], v218, s[32:35], s88 offen offset:0 sc1
    v_mfma_f32_32x32x16_bf16 v[56:71], a[84:87], v[156:159], v[56:71]
    buffer_load_dwordx4 v[156:159], v219, s[32:35], s88 offen offset:0 sc1
    s_waitcnt vmcnt(27)
    v_mfma_f32_32x32x16_bf16 v[8:23], a[88:91], v[160:163], v[8:23]
    v_mfma_f32_32x32x16_bf16 v[24:39], a[88:91], v[164:167], v[24:39]
    v_mfma_f32_32x32x16_bf16 v[40:55], a[92:95], v[160:163], v[40:55]
    buffer_load_dwordx4 v[160:163], v218, s[32:35], s88 offen offset:1024 sc1
    v_mfma_f32_32x32x16_bf16 v[56:71], a[92:95], v[164:167], v[56:71]
    buffer_load_dwordx4 v[164:167], v219, s[32:35], s88 offen offset:1024 sc1
    s_waitcnt vmcnt(27)
    v_mfma_f32_32x32x16_bf16 v[8:23], a[96:99], v[168:171], v[8:23]
    v_mfma_f32_32x32x16_bf16 v[24:39], a[96:99], v[172:175], v[24:39]
    v_mfma_f32_32x32x16_bf16 v[40:55], a[100:103], v[168:171], v[40:55]
    buffer_load_dwordx4 v[168:171], v218, s[32:35], s88 offen offset:2048 sc1
    v_mfma_f32_32x32x16_bf16 v[56:71], a[100:103], v[172:175], v[56:71]
    buffer_load_dwordx4 v[172:175], v219, s[32:35], s88 offen offset:2048 sc1
    s_waitcnt vmcnt(27)
    v_mfma_f32_32x32x16_bf16 v[8:23], a[104:107], v[176:179], v[8:23]
    v_mfma_f32_32x32x16_bf16 v[24:39], a[104:107], v[180:183], v[24:39]
    v_mfma_f32_32x32x16_bf16 v[40:55], a[108:111], v[176:179], v[40:55]
    buffer_load_dwordx4 v[176:179], v218, s[32:35], s88 offen offset:3072 sc1
    v_mfma_f32_32x32x16_bf16 v[56:71], a[108:111], v[180:183], v[56:71]
    buffer_load_dwordx4 v[180:183], v219, s[32:35], s88 offen offset:3072 sc1
    s_waitcnt vmcnt(26)
    v_mfma_f32_32x32x16_bf16 v[8:23], a[112:115], v[72:75], v[8:23]
    v_mfma_f32_32x32x16_bf16 v[24:39], a[112:115], v[76:79], v[24:39]
    v_mfma_f32_32x32x16_bf16 v[40:55], a[116:119], v[72:75], v[40:55]
    v_mfma_f32_32x32x16_bf16 v[56:71], a[116:119], v[76:79], v[56:71]
    s_and_b32 s79, s3, 1
    s_lshr_b32 s80, s3, 1
    v_and_b32 v3, 31, v1
    s_lshl_b32 s89, s80, 5
    s_add_u32 s89, s89, s81
    v_add_u32 v3, s89, v3
    v_lshrrev_b32 v4, 5, v1
    v_lshlrev_b32 v4, 2, v4
    s_lshl_b32 s89, s79, 5
    s_add_u32 s89, s89, s82
    v_add_u32 v4, s89, v4
    v_lshlrev_b32 v5, 10, v3
    v_lshl_add_u32 v5, v4, 1, v5
    s_mov_b32 s92, s4
    s_mov_b32 s93, s5
    s_mov_b32 s94, 0x200000
    s_mov_b32 s95, 0x20000
    buffer_load_dwordx2 v[184:185], v5, s[92:95], 0 offen offset:0
    buffer_load_dwordx2 v[186:187], v5, s[92:95], 0 offen offset:16
    buffer_load_dwordx2 v[188:189], v5, s[92:95], 0 offen offset:32
    buffer_load_dwordx2 v[190:191], v5, s[92:95], 0 offen offset:48
    v_lshlrev_b32 v6, 1, v4
    s_mov_b32 s92, s24
    s_mov_b32 s93, s25
    s_mov_b32 s94, 0x400
    s_mov_b32 s95, 0x20000
    buffer_load_dwordx2 v[192:193], v6, s[92:95], 0 offen offset:0
    buffer_load_dwordx2 v[194:195], v6, s[92:95], 0 offen offset:16
    buffer_load_dwordx2 v[196:197], v6, s[92:95], 0 offen offset:32
    buffer_load_dwordx2 v[198:199], v6, s[92:95], 0 offen offset:48
    v_and_b32 v7, 1, v3
    v_lshrrev_b32 v6, 1, v3
    v_lshlrev_b32 v6, 7, v6
    v_lshl_add_u32 v6, v7, 3, v6
    v_add_u32 v6, 15204352, v6
    buffer_load_dwordx2 v[200:201], v6, s[32:35], 0 offen sc1
    s_cmp_lg_u32 s3, 0
    s_cbranch_scc1 Lw044
    s_lshr_b32 s45, s82, 6
    s_lshl_b32 s45, s45, 1
    s_lshr_b32 s89, s81, 10
    s_add_u32 s45, s45, s89
    s_lshl_b32 s45, s45, 13
    s_add_u32 s45, s45, 15073280
    v_lshl_add_u32 v212, v1, 7, s45
    buffer_load_dword v213, v212, s[32:35], 0 offen sc1
Lw044:
    s_cmp_lg_u32 s2, 0
    s_cbranch_scc1 Lfar45
    v_lshlrev_b32 v214, 7, v0
    v_add_u32 v214, 14893056, v214
    buffer_load_dword v215, v214, s[32:35], 0 offen sc1
Lfar45:
    s_waitcnt vmcnt(33)
    v_mfma_f32_32x32x16_bf16 v[8:23], a[120:123], v[80:83], v[8:23]
    v_mfma_f32_32x32x16_bf16 v[24:39], a[120:123], v[84:87], v[24:39]
    v_mfma_f32_32x32x16_bf16 v[40:55], a[124:127], v[80:83], v[40:55]
    v_mfma_f32_32x32x16_bf16 v[56:71], a[124:127], v[84:87], v[56:71]
    s_waitcnt vmcnt(31)
    v_mfma_f32_32x32x16_bf16 v[8:23], a[128:131], v[88:91], v[8:23]
    v_mfma_f32_32x32x16_bf16 v[24:39], a[128:131], v[92:95], v[24:39]
    v_mfma_f32_32x32x16_bf16 v[40:55], a[132:135], v[88:91], v[40:55]
    v_mfma_f32_32x32x16_bf16 v[56:71], a[132:135], v[92:95], v[56:71]
    s_waitcnt vmcnt(29)
    v_mfma_f32_32x32x16_bf16 v[8:23], a[136:139], v[96:99], v[8:23]
    v_mfma_f32_32x32x16_bf16 v[24:39], a[136:139], v[100:103], v[24:39]
    v_mfma_f32_32x32x16_bf16 v[40:55], a[140:143], v[96:99], v[40:55]
    v_mfma_f32_32x32x16_bf16 v[56:71], a[140:143], v[100:103], v[56:71]
    s_waitcnt vmcnt(27)
    v_mfma_f32_32x32x16_bf16 v[8:23], a[144:147], v[104:107], v[8:23]
    v_mfma_f32_32x32x16_bf16 v[24:39], a[144:147], v[108:111], v[24:39]
    v_mfma_f32_32x32x16_bf16 v[40:55], a[148:151], v[104:107], v[40:55]
    v_mfma_f32_32x32x16_bf16 v[56:71], a[148:151], v[108:111], v[56:71]
    s_waitcnt vmcnt(25)
    v_mfma_f32_32x32x16_bf16 v[8:23], a[152:155], v[112:115], v[8:23]
    v_mfma_f32_32x32x16_bf16 v[24:39], a[152:155], v[116:119], v[24:39]
    v_mfma_f32_32x32x16_bf16 v[40:55], a[156:159], v[112:115], v[40:55]
    v_mfma_f32_32x32x16_bf16 v[56:71], a[156:159], v[116:119], v[56:71]
    s_waitcnt vmcnt(23)
    v_mfma_f32_32x32x16_bf16 v[8:23], a[160:163], v[120:123], v[8:23]
    v_mfma_f32_32x32x16_bf16 v[24:39], a[160:163], v[124:127], v[24:39]
    v_mfma_f32_32x32x16_bf16 v[40:55], a[164:167], v[120:123], v[40:55]
    v_mfma_f32_32x32x16_bf16 v[56:71], a[164:167], v[124:127], v[56:71]
    s_waitcnt vmcnt(21)
    v_mfma_f32_32x32x16_bf16 v[8:23], a[168:171], v[128:131], v[8:23]
    v_mfma_f32_32x32x16_bf16 v[24:39], a[168:171], v[132:135], v[24:39]
    v_mfma_f32_32x32x16_bf16 v[40:55], a[172:175], v[128:131], v[40:55]
    v_mfma_f32_32x32x16_bf16 v[56:71], a[172:175], v[132:135], v[56:71]
    s_waitcnt vmcnt(19)
    v_mfma_f32_32x32x16_bf16 v[8:23], a[176:179], v[136:139], v[8:23]
    v_mfma_f32_32x32x16_bf16 v[24:39], a[176:179], v[140:143], v[24:39]
    v_mfma_f32_32x32x16_bf16 v[40:55], a[180:183], v[136:139], v[40:55]
    v_mfma_f32_32x32x16_bf16 v[56:71], a[180:183], v[140:143], v[56:71]
    s_waitcnt vmcnt(17)
    v_mfma_f32_32x32x16_bf16 v[8:23], a[184:187], v[144:147], v[8:23]
    v_mfma_f32_32x32x16_bf16 v[24:39], a[184:187], v[148:151], v[24:39]
    v_mfma_f32_32x32x16_bf16 v[40:55], a[188:191], v[144:147], v[40:55]
    v_mfma_f32_32x32x16_bf16 v[56:71], a[188:191], v[148:151], v[56:71]
    s_cmp_lg_u32 s3, 0
    s_cbranch_scc1 Lw046
    s_waitcnt vmcnt(0)
    s_mov_b32 s17, 0
Lpc47:
    v_cmp_ne_u32 vcc, s16, v213
    s_nop 1
    s_mov_b64 s[90:91], vcc
    s_cmp_eq_u64 s[90:91], 0
    s_cbranch_scc1 Lpd48
    s_add_u32 s17, s17, 1
    s_cmp_gt_u32 s17, 100000
    s_cbranch_scc1 Lpd48
    s_sleep 2
    buffer_load_dword v213, v212, s[32:35], 0 offen sc1
    s_waitcnt vmcnt(0)
    s_branch Lpc47
Lpd48:
    v_lshrrev_b32 v6, 3, v1
    v_add_u32 v6, s82, v6
    v_lshlrev_b32 v6, 12, v6
    v_and_b32 v7, 7, v1
    v_lshl_add_u32 v6, v7, 4, v6
    s_lshl_b32 s89, s81, 1
    s_add_u32 s89, s89, 2097152
    buffer_load_dwordx4 v[220:223], v6, s[32:35], s89 offen sc1
    s_add_u32 s89, s89, 32768
    buffer_load_dwordx4 v[224:227], v6, s[32:35], s89 offen sc1
    s_add_u32 s89, s89, 32768
    buffer_load_dwordx4 v[228:231], v6, s[32:35], s89 offen sc1
    s_add_u32 s89, s89, 32768
    buffer_load_dwordx4 v[232:235], v6, s[32:35], s89 offen sc1
    s_add_u32 s89, s89, 32768
    buffer_load_dwordx4 v[236:239], v6, s[32:35], s89 offen sc1
    s_add_u32 s89, s89, 32768
    buffer_load_dwordx4 v[240:243], v6, s[32:35], s89 offen sc1
    s_add_u32 s89, s89, 32768
    buffer_load_dwordx4 v[244:247], v6, s[32:35], s89 offen sc1
    s_add_u32 s89, s89, 32768
    buffer_load_dwordx4 v[248:251], v6, s[32:35], s89 offen sc1
Lw046:
    s_waitcnt vmcnt(15)
    v_mfma_f32_32x32x16_bf16 v[8:23], a[192:195], v[152:155], v[8:23]
    v_mfma_f32_32x32x16_bf16 v[24:39], a[192:195], v[156:159], v[24:39]
    v_mfma_f32_32x32x16_bf16 v[40:55], a[196:199], v[152:155], v[40:55]
    v_mfma_f32_32x32x16_bf16 v[56:71], a[196:199], v[156:159], v[56:71]
    s_waitcnt vmcnt(13)
    v_mfma_f32_32x32x16_bf16 v[8:23], a[200:203], v[160:163], v[8:23]
    v_mfma_f32_32x32x16_bf16 v[24:39], a[200:203], v[164:167], v[24:39]
    v_mfma_f32_32x32x16_bf16 v[40:55], a[204:207], v[160:163], v[40:55]
    v_mfma_f32_32x32x16_bf16 v[56:71], a[204:207], v[164:167], v[56:71]
    s_waitcnt vmcnt(11)
    v_mfma_f32_32x32x16_bf16 v[8:23], a[208:211], v[168:171], v[8:23]
    v_mfma_f32_32x32x16_bf16 v[24:39], a[208:211], v[172:175], v[24:39]
    v_mfma_f32_32x32x16_bf16 v[40:55], a[212:215], v[168:171], v[40:55]
    v_mfma_f32_32x32x16_bf16 v[56:71], a[212:215], v[172:175], v[56:71]
    s_waitcnt vmcnt(9)
    v_mfma_f32_32x32x16_bf16 v[8:23], a[216:219], v[176:179], v[8:23]
    v_mfma_f32_32x32x16_bf16 v[24:39], a[216:219], v[180:183], v[24:39]
    v_mfma_f32_32x32x16_bf16 v[40:55], a[220:223], v[176:179], v[40:55]
    v_mfma_f32_32x32x16_bf16 v[56:71], a[220:223], v[180:183], v[56:71]
    s_barrier
    v_lshlrev_b32 v6, 4, v1
    s_lshl_b32 s89, s3, 12
    v_add_u32 v7, s89, v6
    s_cmp_eq_u32 s3, 0
    s_cbranch_scc1 Lown49
    s_nop 2
    ds_write_b128 v7, v[8:11] offset:8192
    ds_write_b128 v7, v[12:15] offset:9216
    ds_write_b128 v7, v[16:19] offset:10240
    ds_write_b128 v7, v[20:23] offset:11264
    s_branch Lnx50
Lown49:
    s_nop 7
    v_mov_b64 v[72:73], v[8:9]
    v_mov_b64 v[74:75], v[10:11]
    v_mov_b64 v[76:77], v[12:13]
    v_mov_b64 v[78:79], v[14:15]
    v_mov_b64 v[80:81], v[16:17]
    v_mov_b64 v[82:83], v[18:19]
    v_mov_b64 v[84:85], v[20:21]
    v_mov_b64 v[86:87], v[22:23]
Lnx50:
    s_cmp_eq_u32 s3, 1
    s_cbranch_scc1 Lown51
    ds_write_b128 v7, v[40:43] offset:24576
    ds_write_b128 v7, v[44:47] offset:25600
    ds_write_b128 v7, v[48:51] offset:26624
    ds_write_b128 v7, v[52:55] offset:27648
    s_branch Lnx52
Lown51:
    v_mov_b64 v[72:73], v[40:41]
    v_mov_b64 v[74:75], v[42:43]
    v_mov_b64 v[76:77], v[44:45]
    v_mov_b64 v[78:79], v[46:47]
    v_mov_b64 v[80:81], v[48:49]
    v_mov_b64 v[82:83], v[50:51]
    v_mov_b64 v[84:85], v[52:53]
    v_mov_b64 v[86:87], v[54:55]
Lnx52:
    s_cmp_eq_u32 s3, 2
    s_cbranch_scc1 Lown53
    ds_write_b128 v7, v[24:27] offset:40960
    ds_write_b128 v7, v[28:31] offset:41984
    ds_write_b128 v7, v[32:35] offset:43008
    ds_write_b128 v7, v[36:39] offset:44032
    s_branch Lnx54
Lown53:
    v_mov_b64 v[72:73], v[24:25]
    v_mov_b64 v[74:75], v[26:27]
    v_mov_b64 v[76:77], v[28:29]
    v_mov_b64 v[78:79], v[30:31]
    v_mov_b64 v[80:81], v[32:33]
    v_mov_b64 v[82:83], v[34:35]
    v_mov_b64 v[84:85], v[36:37]
    v_mov_b64 v[86:87], v[38:39]
Lnx54:
    s_cmp_eq_u32 s3, 3
    s_cbranch_scc1 Lown55
    ds_write_b128 v7, v[56:59] offset:57344
    ds_write_b128 v7, v[60:63] offset:58368
    ds_write_b128 v7, v[64:67] offset:59392
    ds_write_b128 v7, v[68:71] offset:60416
    s_branch Lnx56
Lown55:
    v_mov_b64 v[72:73], v[56:57]
    v_mov_b64 v[74:75], v[58:59]
    v_mov_b64 v[76:77], v[60:61]
    v_mov_b64 v[78:79], v[62:63]
    v_mov_b64 v[80:81], v[64:65]
    v_mov_b64 v[82:83], v[66:67]
    v_mov_b64 v[84:85], v[68:69]
    v_mov_b64 v[86:87], v[70:71]
Lnx56:
    s_cmp_lg_u32 s3, 0
    s_cbranch_scc1 Lw057
    s_waitcnt vmcnt(0)
    ds_write_b128 v6, v[220:223] offset:0
    ds_write_b128 v6, v[224:227] offset:1024
    ds_write_b128 v6, v[228:231] offset:2048
    ds_write_b128 v6, v[232:235] offset:3072
    ds_write_b128 v6, v[236:239] offset:4096
    ds_write_b128 v6, v[240:243] offset:5120
    ds_write_b128 v6, v[244:247] offset:6144
    ds_write_b128 v6, v[248:251] offset:7168
Lw057:
    s_waitcnt lgkmcnt(0)
    s_barrier
    s_add_u32 s89, s3, 1
    s_and_b32 s89, s89, 3
    s_lshl_b32 s89, s89, 12
    s_lshl_b32 s45, s3, 14
    s_add_u32 s89, s89, s45
    v_add_u32 v7, s89, v6
    ds_read_b128 v[88:91], v7 offset:8192
    ds_read_b128 v[92:95], v7 offset:9216
    ds_read_b128 v[96:99], v7 offset:10240
    ds_read_b128 v[100:103], v7 offset:11264
    s_add_u32 s89, s3, 2
    s_and_b32 s89, s89, 3
    s_lshl_b32 s89, s89, 12
    s_lshl_b32 s45, s3, 14
    s_add_u32 s89, s89, s45
    v_add_u32 v7, s89, v6
    ds_read_b128 v[104:107], v7 offset:8192
    ds_read_b128 v[108:111], v7 offset:9216
    ds_read_b128 v[112:115], v7 offset:10240
    ds_read_b128 v[116:119], v7 offset:11264
    s_add_u32 s89, s3, 3
    s_and_b32 s89, s89, 3
    s_lshl_b32 s89, s89, 12
    s_lshl_b32 s45, s3, 14
    s_add_u32 s89, s89, s45
    v_add_u32 v7, s89, v6
    ds_read_b128 v[120:123], v7 offset:8192
    ds_read_b128 v[124:127], v7 offset:9216
    ds_read_b128 v[128:131], v7 offset:10240
    ds_read_b128 v[132:135], v7 offset:11264
    v_lshrrev_b32 v6, 5, v1
    v_lshlrev_b32 v6, 2, v6
    v_bfe_u32 v7, v1, 2, 2
    v_add_u32 v6, v6, v7
    s_lshl_b32 s89, s79, 5
    v_add_u32 v6, s89, v6
    v_lshlrev_b32 v6, 7, v6
    v_bfe_u32 v7, v1, 4, 1
    v_lshl_add_u32 v6, v7, 5, v6
    v_and_b32 v7, 3, v1
    v_lshl_add_u32 v6, v7, 3, v6
    s_lshl_b32 s89, s80, 6
    v_add_u32 v6, s89, v6
    ds_read_b64_tr_b16 v[136:137], v6 offset:0
    ds_read_b64_tr_b16 v[138:139], v6 offset:1024
    ds_read_b64_tr_b16 v[140:141], v6 offset:2048
    ds_read_b64_tr_b16 v[142:143], v6 offset:3072
    s_waitcnt vmcnt(0)
    v_and_b32 v201, 0xffff0000, v200
    v_lshlrev_b32 v200, 16, v200
    v_rcp_f32 v201, v201
    s_waitcnt lgkmcnt(12)
    v_pk_add_f32 v[72:73], v[72:73], v[88:89]
    v_pk_add_f32 v[74:75], v[74:75], v[90:91]
    v_pk_add_f32 v[76:77], v[76:77], v[92:93]
    v_pk_add_f32 v[78:79], v[78:79], v[94:95]
    v_pk_add_f32 v[80:81], v[80:81], v[96:97]
    v_pk_add_f32 v[82:83], v[82:83], v[98:99]
    v_pk_add_f32 v[84:85], v[84:85], v[100:101]
    v_pk_add_f32 v[86:87], v[86:87], v[102:103]
    v_mul_f32 v202, v200, v201
    v_xor_b32 v202, 0x80000000, v202
    s_waitcnt lgkmcnt(4)
    v_pk_add_f32 v[104:105], v[104:105], v[120:121]
    v_pk_add_f32 v[106:107], v[106:107], v[122:123]
    v_pk_add_f32 v[108:109], v[108:109], v[124:125]
    v_pk_add_f32 v[110:111], v[110:111], v[126:127]
    v_pk_add_f32 v[112:113], v[112:113], v[128:129]
    v_pk_add_f32 v[114:115], v[114:115], v[130:131]
    v_pk_add_f32 v[116:117], v[116:117], v[132:133]
    v_pk_add_f32 v[118:119], v[118:119], v[134:135]
    v_pk_add_f32 v[72:73], v[72:73], v[104:105]
    v_pk_add_f32 v[74:75], v[74:75], v[106:107]
    v_pk_add_f32 v[76:77], v[76:77], v[108:109]
    v_pk_add_f32 v[78:79], v[78:79], v[110:111]
    v_pk_add_f32 v[80:81], v[80:81], v[112:113]
    v_pk_add_f32 v[82:83], v[82:83], v[114:115]
    v_pk_add_f32 v[84:85], v[84:85], v[116:117]
    v_pk_add_f32 v[86:87], v[86:87], v[118:119]
    s_waitcnt lgkmcnt(0)
    s_mov_b32 s92, s26
    s_mov_b32 s93, s27
    s_mov_b32 s94, 0x200000
    s_mov_b32 s95, 0x20000
    v_lshlrev_b32 v144, 16, v184
    v_and_b32 v145, 0xffff0000, v184
    v_lshlrev_b32 v148, 16, v192
    v_and_b32 v149, 0xffff0000, v192
    v_lshlrev_b32 v152, 16, v136
    v_and_b32 v153, 0xffff0000, v136
    v_lshlrev_b32 v146, 16, v185
    v_and_b32 v147, 0xffff0000, v185
    v_lshlrev_b32 v150, 16, v193
    v_and_b32 v151, 0xffff0000, v193
    v_lshlrev_b32 v154, 16, v137
    v_and_b32 v155, 0xffff0000, v137
    v_add_f32 v72, v72, v148
    v_add_f32 v73, v73, v149
    v_add_f32 v74, v74, v150
    v_add_f32 v75, v75, v151
    v_mul_f32 v156, 0xbfb8aa3b, v72
    v_mul_f32 v157, 0xbfb8aa3b, v73
    v_mul_f32 v158, 0xbfb8aa3b, v74
    v_mul_f32 v159, 0xbfb8aa3b, v75
    v_exp_f32 v156, v156
    v_exp_f32 v157, v157
    v_exp_f32 v158, v158
    v_exp_f32 v159, v159
    v_fma_f32 v148, v144, v201, v202
    v_fma_f32 v149, v145, v201, v202
    v_fma_f32 v150, v146, v201, v202
    v_fma_f32 v151, v147, v201, v202
    v_add_f32 v156, 1.0, v156
    v_add_f32 v157, 1.0, v157
    v_add_f32 v158, 1.0, v158
    v_add_f32 v159, 1.0, v159
    v_rcp_f32 v156, v156
    v_rcp_f32 v157, v157
    v_rcp_f32 v158, v158
    v_rcp_f32 v159, v159
    v_mul_f32 v148, v148, v152
    v_mul_f32 v149, v149, v153
    v_mul_f32 v150, v150, v154
    v_mul_f32 v151, v151, v155
    v_mul_f32 v156, v156, v72
    v_mul_f32 v157, v157, v73
    v_mul_f32 v158, v158, v74
    v_mul_f32 v159, v159, v75
    v_fma_f32 v144, v148, v156, v144
    v_fma_f32 v145, v149, v157, v145
    v_fma_f32 v146, v150, v158, v146
    v_fma_f32 v147, v151, v159, v147
    v_cvt_pk_bf16_f32 v160, v144, v145
    v_cvt_pk_bf16_f32 v161, v146, v147
    buffer_store_dwordx2 v[160:161], v5, s[92:95], 0 offen offset:0
    v_lshlrev_b32 v144, 16, v186
    v_and_b32 v145, 0xffff0000, v186
    v_lshlrev_b32 v148, 16, v194
    v_and_b32 v149, 0xffff0000, v194
    v_lshlrev_b32 v152, 16, v138
    v_and_b32 v153, 0xffff0000, v138
    v_lshlrev_b32 v146, 16, v187
    v_and_b32 v147, 0xffff0000, v187
    v_lshlrev_b32 v150, 16, v195
    v_and_b32 v151, 0xffff0000, v195
    v_lshlrev_b32 v154, 16, v139
    v_and_b32 v155, 0xffff0000, v139
    v_add_f32 v76, v76, v148
    v_add_f32 v77, v77, v149
    v_add_f32 v78, v78, v150
    v_add_f32 v79, v79, v151
    v_mul_f32 v156, 0xbfb8aa3b, v76
    v_mul_f32 v157, 0xbfb8aa3b, v77
    v_mul_f32 v158, 0xbfb8aa3b, v78
    v_mul_f32 v159, 0xbfb8aa3b, v79
    v_exp_f32 v156, v156
    v_exp_f32 v157, v157
    v_exp_f32 v158, v158
    v_exp_f32 v159, v159
    v_fma_f32 v148, v144, v201, v202
    v_fma_f32 v149, v145, v201, v202
    v_fma_f32 v150, v146, v201, v202
    v_fma_f32 v151, v147, v201, v202
    v_add_f32 v156, 1.0, v156
    v_add_f32 v157, 1.0, v157
    v_add_f32 v158, 1.0, v158
    v_add_f32 v159, 1.0, v159
    v_rcp_f32 v156, v156
    v_rcp_f32 v157, v157
    v_rcp_f32 v158, v158
    v_rcp_f32 v159, v159
    v_mul_f32 v148, v148, v152
    v_mul_f32 v149, v149, v153
    v_mul_f32 v150, v150, v154
    v_mul_f32 v151, v151, v155
    v_mul_f32 v156, v156, v76
    v_mul_f32 v157, v157, v77
    v_mul_f32 v158, v158, v78
    v_mul_f32 v159, v159, v79
    v_fma_f32 v144, v148, v156, v144
    v_fma_f32 v145, v149, v157, v145
    v_fma_f32 v146, v150, v158, v146
    v_fma_f32 v147, v151, v159, v147
    v_cvt_pk_bf16_f32 v162, v144, v145
    v_cvt_pk_bf16_f32 v163, v146, v147
    buffer_store_dwordx2 v[162:163], v5, s[92:95], 0 offen offset:16
    v_lshlrev_b32 v144, 16, v188
    v_and_b32 v145, 0xffff0000, v188
    v_lshlrev_b32 v148, 16, v196
    v_and_b32 v149, 0xffff0000, v196
    v_lshlrev_b32 v152, 16, v140
    v_and_b32 v153, 0xffff0000, v140
    v_lshlrev_b32 v146, 16, v189
    v_and_b32 v147, 0xffff0000, v189
    v_lshlrev_b32 v150, 16, v197
    v_and_b32 v151, 0xffff0000, v197
    v_lshlrev_b32 v154, 16, v141
    v_and_b32 v155, 0xffff0000, v141
    v_add_f32 v80, v80, v148
    v_add_f32 v81, v81, v149
    v_add_f32 v82, v82, v150
    v_add_f32 v83, v83, v151
    v_mul_f32 v156, 0xbfb8aa3b, v80
    v_mul_f32 v157, 0xbfb8aa3b, v81
    v_mul_f32 v158, 0xbfb8aa3b, v82
    v_mul_f32 v159, 0xbfb8aa3b, v83
    v_exp_f32 v156, v156
    v_exp_f32 v157, v157
    v_exp_f32 v158, v158
    v_exp_f32 v159, v159
    v_fma_f32 v148, v144, v201, v202
    v_fma_f32 v149, v145, v201, v202
    v_fma_f32 v150, v146, v201, v202
    v_fma_f32 v151, v147, v201, v202
    v_add_f32 v156, 1.0, v156
    v_add_f32 v157, 1.0, v157
    v_add_f32 v158, 1.0, v158
    v_add_f32 v159, 1.0, v159
    v_rcp_f32 v156, v156
    v_rcp_f32 v157, v157
    v_rcp_f32 v158, v158
    v_rcp_f32 v159, v159
    v_mul_f32 v148, v148, v152
    v_mul_f32 v149, v149, v153
    v_mul_f32 v150, v150, v154
    v_mul_f32 v151, v151, v155
    v_mul_f32 v156, v156, v80
    v_mul_f32 v157, v157, v81
    v_mul_f32 v158, v158, v82
    v_mul_f32 v159, v159, v83
    v_fma_f32 v144, v148, v156, v144
    v_fma_f32 v145, v149, v157, v145
    v_fma_f32 v146, v150, v158, v146
    v_fma_f32 v147, v151, v159, v147
    v_cvt_pk_bf16_f32 v164, v144, v145
    v_cvt_pk_bf16_f32 v165, v146, v147
    buffer_store_dwordx2 v[164:165], v5, s[92:95], 0 offen offset:32
    v_lshlrev_b32 v144, 16, v190
    v_and_b32 v145, 0xffff0000, v190
    v_lshlrev_b32 v148, 16, v198
    v_and_b32 v149, 0xffff0000, v198
    v_lshlrev_b32 v152, 16, v142
    v_and_b32 v153, 0xffff0000, v142
    v_lshlrev_b32 v146, 16, v191
    v_and_b32 v147, 0xffff0000, v191
    v_lshlrev_b32 v150, 16, v199
    v_and_b32 v151, 0xffff0000, v199
    v_lshlrev_b32 v154, 16, v143
    v_and_b32 v155, 0xffff0000, v143
    v_add_f32 v84, v84, v148
    v_add_f32 v85, v85, v149
    v_add_f32 v86, v86, v150
    v_add_f32 v87, v87, v151
    v_mul_f32 v156, 0xbfb8aa3b, v84
    v_mul_f32 v157, 0xbfb8aa3b, v85
    v_mul_f32 v158, 0xbfb8aa3b, v86
    v_mul_f32 v159, 0xbfb8aa3b, v87
    v_exp_f32 v156, v156
    v_exp_f32 v157, v157
    v_exp_f32 v158, v158
    v_exp_f32 v159, v159
    v_fma_f32 v148, v144, v201, v202
    v_fma_f32 v149, v145, v201, v202
    v_fma_f32 v150, v146, v201, v202
    v_fma_f32 v151, v147, v201, v202
    v_add_f32 v156, 1.0, v156
    v_add_f32 v157, 1.0, v157
    v_add_f32 v158, 1.0, v158
    v_add_f32 v159, 1.0, v159
    v_rcp_f32 v156, v156
    v_rcp_f32 v157, v157
    v_rcp_f32 v158, v158
    v_rcp_f32 v159, v159
    v_mul_f32 v148, v148, v152
    v_mul_f32 v149, v149, v153
    v_mul_f32 v150, v150, v154
    v_mul_f32 v151, v151, v155
    v_mul_f32 v156, v156, v84
    v_mul_f32 v157, v157, v85
    v_mul_f32 v158, v158, v86
    v_mul_f32 v159, v159, v87
    v_fma_f32 v144, v148, v156, v144
    v_fma_f32 v145, v149, v157, v145
    v_fma_f32 v146, v150, v158, v146
    v_fma_f32 v147, v151, v159, v147
    v_cvt_pk_bf16_f32 v166, v144, v145
    v_cvt_pk_bf16_f32 v167, v146, v147
    buffer_store_dwordx2 v[166:167], v5, s[92:95], 0 offen offset:48
    s_cmp_lg_u32 s2, 0
    s_cbranch_scc1 Lfin58
    s_mov_b32 s17, 0
Lpc59:
    v_cmp_ne_u32 vcc, s16, v215
    s_nop 1
    s_mov_b64 s[90:91], vcc
    s_cmp_eq_u64 s[90:91], 0
    s_cbranch_scc1 Lpd60
    s_add_u32 s17, s17, 1
    s_cmp_gt_u32 s17, 100000
    s_cbranch_scc1 Lpd60
    s_sleep 4
    buffer_load_dword v215, v214, s[32:35], 0 offen sc1
    s_waitcnt vmcnt(0)
    s_branch Lpc59
Lpd60:
    s_barrier
    s_cmp_lg_u32 s3, 0
    s_cbranch_scc1 Lfin58
    s_mov_b32 s90, 14712832
    v_mov_b32 v2, 0
    v_writelane_b32 v2, s90, 0
    v_mov_b32 v3, s16
    s_mov_b64 exec, 1
    buffer_store_dword v3, v2, s[32:35], 0 offen sc1
    s_mov_b64 exec, -1
Lfin58:
Lend:
    s_endpgm
.section .rodata,"a"
.p2align 6
.amdhsa_kernel recurrent_scan__ssm_conv_h3__dense_activation_squared_relu__prompt_kernel
  .amdhsa_next_free_vgpr 512
  .amdhsa_next_free_sgpr 102
  .amdhsa_accum_offset 256
  .amdhsa_group_segment_fixed_size 0
  .amdhsa_kernarg_size 112
  .amdhsa_user_sgpr_count 2
  .amdhsa_user_sgpr_kernarg_segment_ptr 1
  .amdhsa_system_sgpr_workgroup_id_x 1
.end_amdhsa_kernel
```
